```python
import torch

def _softmax(x, axis=-1):
    return torch.softmax(x, dim=axis)
def _gelu(x):
    return torch.nn.functional.gelu(x, approximate="tanh")
def _silu(x):
    return torch.nn.functional.silu(x)
def _sigmoid(x):
    return torch.sigmoid(x)
def _layernorm(x, axis=-1, eps=1e-5):
    m = x.mean(dim=axis, keepdim=True)
    v = x.var(dim=axis, keepdim=True, unbiased=False)
    return (x - m) / torch.sqrt(v + eps)
def _scatter_add(tgt, idx, src, axis=0):
    return tgt.clone().index_add_(axis, idx, src)
def _segment_sum(src, seg, n):
    out = torch.zeros((n,) + src.shape[1:], dtype=src.dtype)
    return out.index_add_(0, seg, src)
def _pad(x, pw):
    flat = tuple(v for pair in reversed(pw) for v in pair)
    return torch.nn.functional.pad(x, flat)

kernel_name = 'standalone__cross_network_dcn_v2__recsys'

def setup_inputs():

    _w = (lambda a: (lambda t: t.to(torch.bfloat16) if t.is_floating_point() else t)(torch.as_tensor(a)))
    B, F, D, L = 16384, 26, 16, 6
    Din = min(F * D, 512)
    R = max(Din // 4, 2)
    sc = Din ** -0.5
    return {
        "x0": _w((lambda *s: torch.randn(*s, dtype=torch.bfloat16) * 0.05)(B, Din)),
        "U":  _w((lambda *s: torch.randn(*s, dtype=torch.bfloat16) * 1.6)(L, Din, R) * sc),
        "V":  _w((lambda *s: torch.randn(*s, dtype=torch.bfloat16) * 1.6)(L, R, Din) * sc),
        "bs": _w((lambda *s: torch.randn(*s, dtype=torch.bfloat16) * 0.05)(L, Din)),
    }

def reference(x0, U, V, bs):
    x = x0
    for l in range(U.shape[0]):
        h = torch.einsum('rd,bd->br', V[l], x)
        h = torch.einsum('dr,br->bd', U[l], h)
        x = x0 * (h + bs[l]) + x
    return x
```

```asm
; @launch grid=(256,1,1) block=(256,1,1) lds=162816
.amdgcn_target "amdgcn-amd-amdhsa--gfx950"
.text
.globl standalone__cross_network_dcn_v2__recsys_kernel
.p2align 8
.type standalone__cross_network_dcn_v2__recsys_kernel,@function
standalone__cross_network_dcn_v2__recsys_kernel:
  s_load_dwordx4 s[4:7], s[0:1], 0
  s_load_dwordx4 s[8:11], s[0:1], 16
  s_load_dwordx4 s[12:15], s[0:1], 32
  s_load_dwordx2 s[16:17], s[0:1], 48
  s_cmp_ge_u32 s2, 256
  s_cbranch_scc1 standalone__cross_network_dcn_v2__recsys_kernel_done
  v_lshrrev_b32 v8, 6, v0
  v_and_b32 v252, 63, v0
  v_readfirstlane_b32 s48, v8
  s_bfe_u32 s50, s2, 0x30003
  s_mul_i32 s50, s50, 4096
  s_cmp_eq_u32 s48, 1
  s_cbranch_scc0 standalone__cross_network_dcn_v2__recsys_kernel_nopf
  s_getpc_b64 s[52:53]
standalone__cross_network_dcn_v2__recsys_kernel_pc4:
  s_sub_u32 s52, s52, standalone__cross_network_dcn_v2__recsys_kernel_pc4-standalone__cross_network_dcn_v2__recsys_kernel
  s_subb_u32 s53, s53, 0
  v_lshlrev_b32 v253, 6, v252
  v_add_u32 v253, s50, v253
  v_min_u32 v253, standalone__cross_network_dcn_v2__recsys_kernel_fb-standalone__cross_network_dcn_v2__recsys_kernel, v253
  v_mov_b32 v251, s53
  v_add_co_u32 v250, vcc, s52, v253
  s_nop 1
  v_addc_co_u32 v251, vcc, 0, v251, vcc
  global_load_dword v254, v[250:251], off
standalone__cross_network_dcn_v2__recsys_kernel_nopf:
  s_mul_i32 s55, s2, 53248
  s_lshr_b32 s51, s2, 3
  s_and_b32 s50, s2, 2
  s_lshl_b32 s50, s50, 4
  s_add_u32 s51, s51, s50
  s_cmp_eq_u32 s2, 6
  s_cselect_b32 s3, 64, 0xff
  s_and_b32 s50, s2, 5
  s_cmp_eq_u32 s50, 0
  s_cselect_b32 s3, s51, s3
  s_cmp_lt_u32 s3, 13
  s_cselect_b32 s18, 13, 52
  s_cmp_lt_u32 s3, 65
  s_cselect_b32 s18, s18, 0
  s_cmp_eq_u32 s48, 3
  s_cbranch_scc0 standalone__cross_network_dcn_v2__recsys_kernel_M
  s_cmp_lt_u32 s3, 13
  s_cbranch_scc1 standalone__cross_network_dcn_v2__recsys_kernel_Rp0
  v_lshlrev_b32 v0, 4, v252
  v_lshrrev_b32 v8, 4, v252
  v_and_b32 v9, 3, v252
  v_xor_b32 v9, v9, v8
  v_lshlrev_b32 v3, 4, v9
  v_lshrrev_b32 v9, 3, v252
  v_and_b32 v9, 1, v9
  v_lshlrev_b32 v9, 2, v9
  v_or_b32 v8, v8, v9
  v_mul_u32_u24 v8, 1664, v8
  v_and_b32 v9, 4, v252
  v_lshlrev_b32 v9, 4, v9
  v_add3_u32 v3, v3, v8, v9
  s_waitcnt lgkmcnt(0)
  s_mov_b32 s20, s4
  s_mov_b32 s21, s5
  s_mov_b32 s22, 13631488
  s_mov_b32 s23, 0x20000
  s_mov_b32 s32, s8
  s_mov_b32 s33, s9
  s_mov_b32 s34, 519168
  s_mov_b32 s35, 0x20000
standalone__cross_network_dcn_v2__recsys_kernel_Rnp0:
  s_add_u32 s50, s55, 0
  s_mov_b32 m0, 14336
  s_nop 0
  buffer_load_dwordx4 v3, s[20:23], s50 offen offset:0 nt lds
  s_mov_b32 m0, 15232
  s_nop 0
  buffer_load_dwordx4 v3, s[20:23], s50 offen offset:128 nt lds
  s_mov_b32 m0, 16128
  s_nop 0
  buffer_load_dwordx4 v3, s[20:23], s50 offen offset:256 nt lds
  s_mov_b32 m0, 17024
  s_nop 0
  buffer_load_dwordx4 v3, s[20:23], s50 offen offset:384 nt lds
  s_mov_b32 m0, 17920
  s_nop 0
  buffer_load_dwordx4 v3, s[20:23], s50 offen offset:512 nt lds
  s_mov_b32 m0, 18816
  s_nop 0
  buffer_load_dwordx4 v3, s[20:23], s50 offen offset:640 nt lds
  s_mov_b32 m0, 19712
  s_nop 0
  buffer_load_dwordx4 v3, s[20:23], s50 offen offset:768 nt lds
  s_mov_b32 m0, 20608
  s_nop 0
  buffer_load_dwordx4 v3, s[20:23], s50 offen offset:896 nt lds
  s_mov_b32 m0, 21504
  s_nop 0
  buffer_load_dwordx4 v3, s[20:23], s50 offen offset:1024 nt lds
  s_mov_b32 m0, 22400
  s_nop 0
  buffer_load_dwordx4 v3, s[20:23], s50 offen offset:1152 nt lds
  s_mov_b32 m0, 23296
  s_nop 0
  buffer_load_dwordx4 v3, s[20:23], s50 offen offset:1280 nt lds
  s_mov_b32 m0, 24192
  s_nop 0
  buffer_load_dwordx4 v3, s[20:23], s50 offen offset:1408 nt lds
  s_mov_b32 m0, 25088
  s_nop 0
  buffer_load_dwordx4 v3, s[20:23], s50 offen offset:1536 nt lds
  s_add_u32 s50, s55, 13312
  s_mov_b32 m0, 27648
  s_nop 0
  buffer_load_dwordx4 v3, s[20:23], s50 offen offset:0 nt lds
  s_mov_b32 m0, 28544
  s_nop 0
  buffer_load_dwordx4 v3, s[20:23], s50 offen offset:128 nt lds
  s_mov_b32 m0, 29440
  s_nop 0
  buffer_load_dwordx4 v3, s[20:23], s50 offen offset:256 nt lds
  s_mov_b32 m0, 30336
  s_nop 0
  buffer_load_dwordx4 v3, s[20:23], s50 offen offset:384 nt lds
  s_mov_b32 m0, 31232
  s_nop 0
  buffer_load_dwordx4 v3, s[20:23], s50 offen offset:512 nt lds
  s_mov_b32 m0, 32128
  s_nop 0
  buffer_load_dwordx4 v3, s[20:23], s50 offen offset:640 nt lds
  s_mov_b32 m0, 33024
  s_nop 0
  buffer_load_dwordx4 v3, s[20:23], s50 offen offset:768 nt lds
  s_mov_b32 m0, 33920
  s_nop 0
  buffer_load_dwordx4 v3, s[20:23], s50 offen offset:896 nt lds
  s_mov_b32 m0, 34816
  s_nop 0
  buffer_load_dwordx4 v3, s[20:23], s50 offen offset:1024 nt lds
  s_mov_b32 m0, 35712
  s_nop 0
  buffer_load_dwordx4 v3, s[20:23], s50 offen offset:1152 nt lds
  s_mov_b32 m0, 36608
  s_nop 0
  buffer_load_dwordx4 v3, s[20:23], s50 offen offset:1280 nt lds
  s_mov_b32 m0, 37504
  s_nop 0
  buffer_load_dwordx4 v3, s[20:23], s50 offen offset:1408 nt lds
  s_mov_b32 m0, 38400
  s_nop 0
  buffer_load_dwordx4 v3, s[20:23], s50 offen offset:1536 nt lds
  s_cmp_eq_u32 s18, 52
  s_cbranch_scc1 standalone__cross_network_dcn_v2__recsys_kernel_Rp0
  s_cmp_eq_u32 s18, 13
  s_cbranch_scc1 standalone__cross_network_dcn_v2__recsys_kernel_Rnba
standalone__cross_network_dcn_v2__recsys_kernel_Rnp0b:
  s_barrier
standalone__cross_network_dcn_v2__recsys_kernel_Rnba:
  s_mov_b32 s24, s12
  s_mov_b32 s25, s13
  s_mov_b32 s26, 13631488
  s_mov_b32 s27, 0x20000
  s_mov_b32 s28, s16
  s_mov_b32 s29, s17
  s_mov_b32 s30, 1051392
  s_mov_b32 s31, 0x20000
  s_mov_b32 s36, s6
  s_mov_b32 s37, s7
  s_mov_b32 s38, 519168
  s_mov_b32 s39, 0x20000
  s_mov_b32 s40, s10
  s_mov_b32 s41, s11
  s_mov_b32 s42, 4992
  s_mov_b32 s43, 0x20000
  s_mov_b32 s44, s14
  s_mov_b32 s45, s15
  s_mov_b32 s46, 256
  s_mov_b32 s47, 0x20000
  v_and_b32 v240, 31, v252
  v_lshrrev_b32 v241, 5, v252
  v_lshrrev_b32 v242, 1, v240
  v_and_b32 v242, 7, v242
  v_and_b32 v243, 1, v240
  v_lshrrev_b32 v244, 4, v240
  v_mul_u32_u24 v244, 13312, v244
  v_and_b32 v246, 3, v242
  v_lshlrev_b32 v247, 8, v246
  v_add_u32 v244, v244, v247
  v_lshrrev_b32 v247, 2, v242
  v_lshlrev_b32 v247, 7, v247
  v_add_u32 v244, v244, v247
  v_mul_u32_u24 v247, 6144, v243
  v_add_u32 v244, v244, v247
  v_add_u32 v244, 14336, v244
  v_xor_b32 v245, v241, v246
  v_lshlrev_b32 v245, 4, v245
  v_lshlrev_b32 v246, 6, v243
  v_add3_u32 v4, v244, v246, v245
  v_xor_b32 v247, 32, v245
  v_add3_u32 v5, v244, v246, v247
  v_xor_b32 v246, 64, v246
  v_lshlrev_b32 v243, 10, v243
  v_add3_u32 v244, v244, v246, v243
  v_add_u32 v6, v244, v245
  v_add_u32 v7, v244, v247
  v_and_b32 v242, 0x13, v240
  v_and_b32 v243, 4, v240
  v_lshlrev_b32 v243, 1, v243
  v_or_b32 v242, v242, v243
  v_and_b32 v243, 8, v240
  v_lshrrev_b32 v243, 1, v243
  v_or_b32 v242, v242, v243
  v_lshlrev_b32 v243, 1, v242
  buffer_load_ushort v220, v243, s[40:43], 0 offen offset:576
  buffer_load_ushort v221, v243, s[40:43], 0 offen offset:640
  buffer_load_ushort v222, v243, s[40:43], 0 offen offset:704
  buffer_load_ushort v223, v243, s[40:43], 0 offen offset:768
  v_mul_u32_u24 v242, 208, v242
  v_lshlrev_b32 v243, 4, v241
  v_add3_u32 v10, v242, v243, 0
  v_add_u32 v10, 129024, v10
  v_and_b32 v240, 15, v252
  v_lshrrev_b32 v241, 4, v252
  v_lshrrev_b32 v242, 1, v240
  v_and_b32 v243, 1, v240
  v_and_b32 v245, 3, v242
  v_lshlrev_b32 v244, 8, v245
  v_lshrrev_b32 v246, 2, v242
  v_lshlrev_b32 v246, 7, v246
  v_add_u32 v244, v244, v246
  v_xor_b32 v245, v241, v245
  v_lshlrev_b32 v245, 4, v245
  v_add_u32 v244, v244, v245
  v_add_u32 v244, 14336, v244
  v_mul_u32_u24 v246, 6144, v243
  v_add_u32 v244, v244, v246
  v_xor_b32 v243, 0, v243
  v_lshlrev_b32 v243, 6, v243
  v_add_u32 v8, v244, v243
  v_lshrrev_b32 v242, 1, v240
  v_and_b32 v243, 1, v240
  v_and_b32 v245, 3, v242
  v_lshlrev_b32 v244, 8, v245
  v_lshrrev_b32 v246, 2, v242
  v_lshlrev_b32 v246, 7, v246
  v_add_u32 v244, v244, v246
  v_xor_b32 v245, v241, v245
  v_lshlrev_b32 v245, 4, v245
  v_add_u32 v244, v244, v245
  v_add_u32 v244, 14336, v244
  v_mul_u32_u24 v246, 7168, v243
  v_add_u32 v244, v244, v246
  v_xor_b32 v243, 1, v243
  v_lshlrev_b32 v243, 6, v243
  v_add_u32 v9, v244, v243
  v_lshlrev_b32 v242, 4, v240
  v_lshlrev_b32 v243, 2, v241
  v_add3_u32 v2, v242, v243, 0
  v_add_u32 v2, 6144, v2
  v_lshlrev_b32 v246, 2, v252
  v_subrev_u32 v246, 128, v246
  v_add_u32 v247, 128, v0
  v_cmp_gt_u32 vcc, 32, v252
  s_nop 1
  v_cndmask_b32 v1, v246, v247, vcc
  v_lshrrev_b32 v238, 2, v240
  v_lshlrev_b32 v238, 1, v238
  v_and_b32 v239, 1, v240
  v_add_u32 v238, v238, v239
  v_lshrrev_b32 v239, 1, v240
  v_and_b32 v239, 1, v239
  v_lshrrev_b32 v242, 1, v238
  v_and_b32 v243, 1, v238
  v_and_b32 v245, 3, v242
  v_lshlrev_b32 v244, 8, v245
  v_lshrrev_b32 v246, 2, v242
  v_lshlrev_b32 v246, 7, v246
  v_add_u32 v244, v244, v246
  v_xor_b32 v245, v241, v245
  v_lshlrev_b32 v245, 4, v245
  v_add_u32 v244, v244, v245
  v_add_u32 v244, 147456, v244
  v_add_u32 v246, 6, v239
  v_mul_u32_u24 v246, v246, v243
  v_lshlrev_b32 v246, 10, v246
  v_add_u32 v244, v244, v246
  v_xor_b32 v243, v239, v243
  v_lshlrev_b32 v243, 6, v243
  v_add_u32 v232, v244, v243
  v_lshrrev_b32 v238, 5, v252
  v_mul_u32_u24 v238, 7168, v238
  v_and_b32 v239, 31, v252
  v_lshlrev_b32 v239, 4, v239
  v_add3_u32 v238, v238, v239, 0
  v_add_u32 v233, 6656, v238
  v_mov_b32 v244, 0x3f80
  v_mov_b32 v245, 0
  v_mov_b32 v246, 0
  v_mov_b32 v247, 0
  v_mov_b32 v243, v233
  s_cmp_lt_u32 s3, 13
  s_cselect_b32 s50, 0, 64
  s_lshl_b32 s50, s3, 2
  v_mov_b32 v236, 1
  v_mov_b32 v237, s50
  v_mov_b32 v12, 1.0
  v_mov_b32 v13, 1.0
  v_mov_b32 v14, 1.0
  v_mov_b32 v15, 1.0
  v_mov_b32 v16, 1.0
  v_mov_b32 v17, 1.0
  v_mov_b32 v18, 1.0
  v_mov_b32 v19, 1.0
  v_mov_b32 v20, 1.0
  v_mov_b32 v21, 1.0
  v_mov_b32 v22, 1.0
  v_mov_b32 v23, 1.0
  v_mov_b32 v24, 1.0
  v_mov_b32 v25, 1.0
  v_mov_b32 v26, 1.0
  v_mov_b32 v27, 1.0
  v_mov_b32 v28, 1.0
  v_mov_b32 v29, 1.0
  v_mov_b32 v30, 1.0
  v_mov_b32 v31, 1.0
  v_mov_b32 v32, 1.0
  v_mov_b32 v33, 1.0
  v_mov_b32 v34, 1.0
  v_mov_b32 v35, 1.0
  v_mov_b32 v36, 1.0
  v_mov_b32 v37, 1.0
  v_mov_b32 v38, 1.0
  v_mov_b32 v39, 1.0
  v_mov_b32 v40, 1.0
  v_mov_b32 v41, 1.0
  v_mov_b32 v42, 1.0
  v_mov_b32 v43, 1.0
  v_mov_b32 v44, 1.0
  v_mov_b32 v45, 1.0
  v_mov_b32 v46, 1.0
  v_mov_b32 v47, 1.0
  v_mov_b32 v48, 1.0
  v_mov_b32 v49, 1.0
  v_mov_b32 v50, 1.0
  v_mov_b32 v51, 1.0
  v_mov_b32 v52, 1.0
  v_mov_b32 v53, 1.0
  v_mov_b32 v54, 1.0
  v_mov_b32 v55, 1.0
  v_mov_b32 v56, 1.0
  v_mov_b32 v57, 1.0
  v_mov_b32 v58, 1.0
  v_mov_b32 v59, 1.0
  v_mov_b32 v60, 1.0
  v_mov_b32 v61, 1.0
  v_mov_b32 v62, 1.0
  v_mov_b32 v63, 1.0
  v_mov_b32 v64, 1.0
  v_mov_b32 v65, 1.0
  v_mov_b32 v66, 1.0
  v_mov_b32 v67, 1.0
  v_mov_b32 v68, 1.0
  v_mov_b32 v69, 1.0
  v_mov_b32 v70, 1.0
  v_mov_b32 v71, 1.0
  v_mov_b32 v72, 1.0
  v_mov_b32 v73, 1.0
  v_mov_b32 v74, 1.0
  v_mov_b32 v75, 1.0
  v_mov_b32 v76, 1.0
  v_mov_b32 v77, 1.0
  v_mov_b32 v78, 1.0
  v_mov_b32 v79, 1.0
  v_mov_b32 v80, 1.0
  v_mov_b32 v81, 1.0
  v_mov_b32 v82, 1.0
  v_mov_b32 v83, 1.0
  v_mov_b32 v84, 1.0
  v_mov_b32 v85, 1.0
  v_mov_b32 v86, 1.0
  v_mov_b32 v87, 1.0
  v_mov_b32 v88, 1.0
  v_mov_b32 v89, 1.0
  v_mov_b32 v90, 1.0
  v_mov_b32 v91, 1.0
  v_mov_b32 v92, 1.0
  v_mov_b32 v93, 1.0
  v_mov_b32 v94, 1.0
  v_mov_b32 v95, 1.0
  v_mov_b32 v96, 1.0
  v_mov_b32 v97, 1.0
  v_mov_b32 v98, 1.0
  v_mov_b32 v99, 1.0
  v_mov_b32 v100, 1.0
  v_mov_b32 v101, 1.0
  v_mov_b32 v102, 1.0
  v_mov_b32 v103, 1.0
  v_mov_b32 v104, 1.0
  v_mov_b32 v105, 1.0
  v_mov_b32 v106, 1.0
  v_mov_b32 v107, 1.0
  v_mov_b32 v108, 1.0
  v_mov_b32 v109, 1.0
  v_mov_b32 v110, 1.0
  v_mov_b32 v111, 1.0
  v_mov_b32 v112, 1.0
  v_mov_b32 v113, 1.0
  v_mov_b32 v114, 1.0
  v_mov_b32 v115, 1.0
  v_mov_b32 v116, 1.0
  v_mov_b32 v117, 1.0
  v_mov_b32 v118, 1.0
  v_mov_b32 v119, 1.0
  v_mov_b32 v120, 1.0
  v_mov_b32 v121, 1.0
  v_mov_b32 v122, 1.0
  v_mov_b32 v123, 1.0
  v_mov_b32 v124, 1.0
  v_mov_b32 v125, 1.0
  v_mov_b32 v126, 1.0
  v_mov_b32 v127, 1.0
  v_mov_b32 v128, 1.0
  v_mov_b32 v129, 1.0
  v_mov_b32 v130, 1.0
  v_mov_b32 v131, 1.0
  v_mov_b32 v132, 1.0
  v_mov_b32 v133, 1.0
  v_mov_b32 v134, 1.0
  v_mov_b32 v135, 1.0
  v_mov_b32 v136, 1.0
  v_mov_b32 v137, 1.0
  v_mov_b32 v138, 1.0
  v_mov_b32 v139, 1.0
  s_mov_b32 s60, 4096
  s_mov_b32 s61, 8192
  s_mov_b32 s62, 12288
  s_mov_b32 s63, 16384
  s_mov_b32 s64, 20480
  s_mov_b32 s65, 24576
  s_mov_b32 s66, 28672
  s_mov_b32 s67, 32768
  s_mov_b32 s68, 36864
  s_mov_b32 s69, 40960
  s_mov_b32 s70, 45056
  s_mov_b32 s50, 140928
  s_mov_b32 s51, 1152
  s_add_u32 s51, s51, s55
  s_mov_b32 s56, s51
  s_add_u32 s57, s51, 13312
  s_add_u32 s58, s51, 26624
  s_add_u32 s59, s51, 39936
  s_mov_b32 s49, 0
  s_cmp_eq_u32 s18, 0
  s_cbranch_scc1 standalone__cross_network_dcn_v2__recsys_kernel_Rnx
  s_cmp_lt_u32 s3, 13
  s_cbranch_scc0 standalone__cross_network_dcn_v2__recsys_kernel_RnC
  s_waitcnt vmcnt(30)
  s_branch standalone__cross_network_dcn_v2__recsys_kernel_Rp1s
standalone__cross_network_dcn_v2__recsys_kernel_RnC:
  s_waitcnt vmcnt(17)
  s_barrier
  s_waitcnt vmcnt(0)
  s_branch standalone__cross_network_dcn_v2__recsys_kernel_Rp1s
standalone__cross_network_dcn_v2__recsys_kernel_Rnx:
  s_waitcnt vmcnt(4)
  s_barrier
  s_waitcnt vmcnt(0)
standalone__cross_network_dcn_v2__recsys_kernel_Rnp1s:
  ds_read_b128 v[144:147], v6 offset:4096
  ds_read_b128 v[152:155], v7 offset:4096
  ds_read_b128 v[160:163], v4 offset:6144
  ds_read_b128 v[168:171], v5 offset:6144
  ds_read_b128 v[248:251], v4 offset:5120
  ds_read_b128 v[252:255], v5 offset:5120
  s_waitcnt lgkmcnt(0)
  v_lshlrev_b32 v140, 16, v144
  v_and_b32 v141, 0xffff0000, v144
  v_lshlrev_b32 v142, 16, v145
  v_and_b32 v143, 0xffff0000, v145
  v_lshlrev_b32 v144, 16, v146
  v_and_b32 v145, 0xffff0000, v146
  v_lshlrev_b32 v146, 16, v147
  v_and_b32 v147, 0xffff0000, v147
  v_lshlrev_b32 v148, 16, v152
  v_and_b32 v149, 0xffff0000, v152
  v_lshlrev_b32 v150, 16, v153
  v_and_b32 v151, 0xffff0000, v153
  v_lshlrev_b32 v152, 16, v154
  v_and_b32 v153, 0xffff0000, v154
  v_lshlrev_b32 v154, 16, v155
  v_and_b32 v155, 0xffff0000, v155
  v_lshlrev_b32 v156, 16, v160
  v_and_b32 v157, 0xffff0000, v160
  v_lshlrev_b32 v158, 16, v161
  v_and_b32 v159, 0xffff0000, v161
  v_lshlrev_b32 v160, 16, v162
  v_and_b32 v161, 0xffff0000, v162
  v_lshlrev_b32 v162, 16, v163
  v_and_b32 v163, 0xffff0000, v163
  v_lshlrev_b32 v164, 16, v168
  v_and_b32 v165, 0xffff0000, v168
  v_lshlrev_b32 v166, 16, v169
  v_and_b32 v167, 0xffff0000, v169
  v_lshlrev_b32 v168, 16, v170
  v_and_b32 v169, 0xffff0000, v170
  v_lshlrev_b32 v170, 16, v171
  v_and_b32 v171, 0xffff0000, v171
  v_lshlrev_b32 v11, 16, v248
  v_and_b32 v248, 0xffff0000, v248
  v_accvgpr_write_b32 a140, v11
  v_accvgpr_write_b32 a141, v248
  v_lshlrev_b32 v11, 16, v249
  v_and_b32 v249, 0xffff0000, v249
  v_accvgpr_write_b32 a142, v11
  v_accvgpr_write_b32 a143, v249
  v_lshlrev_b32 v11, 16, v250
  v_and_b32 v250, 0xffff0000, v250
  v_accvgpr_write_b32 a144, v11
  v_accvgpr_write_b32 a145, v250
  v_lshlrev_b32 v11, 16, v251
  v_and_b32 v251, 0xffff0000, v251
  v_accvgpr_write_b32 a146, v11
  v_accvgpr_write_b32 a147, v251
  v_lshlrev_b32 v11, 16, v252
  v_and_b32 v252, 0xffff0000, v252
  v_accvgpr_write_b32 a148, v11
  v_accvgpr_write_b32 a149, v252
  v_lshlrev_b32 v11, 16, v253
  v_and_b32 v253, 0xffff0000, v253
  v_accvgpr_write_b32 a150, v11
  v_accvgpr_write_b32 a151, v253
  v_lshlrev_b32 v11, 16, v254
  v_and_b32 v254, 0xffff0000, v254
  v_accvgpr_write_b32 a152, v11
  v_accvgpr_write_b32 a153, v254
  v_lshlrev_b32 v11, 16, v255
  v_and_b32 v255, 0xffff0000, v255
  v_accvgpr_write_b32 a154, v11
  v_accvgpr_write_b32 a155, v255
  ds_read_b128 v[248:251], v6 offset:5120
  ds_read_b128 v[252:255], v7 offset:5120
  s_waitcnt lgkmcnt(0)
  v_lshlrev_b32 v11, 16, v248
  v_and_b32 v248, 0xffff0000, v248
  v_accvgpr_write_b32 a156, v11
  v_accvgpr_write_b32 a157, v248
  v_lshlrev_b32 v11, 16, v249
  v_and_b32 v249, 0xffff0000, v249
  v_accvgpr_write_b32 a158, v11
  v_accvgpr_write_b32 a159, v249
  v_lshlrev_b32 v11, 16, v250
  v_and_b32 v250, 0xffff0000, v250
  v_accvgpr_write_b32 a160, v11
  v_accvgpr_write_b32 a161, v250
  v_lshlrev_b32 v11, 16, v251
  v_and_b32 v251, 0xffff0000, v251
  v_accvgpr_write_b32 a162, v11
  v_accvgpr_write_b32 a163, v251
  v_lshlrev_b32 v11, 16, v252
  v_and_b32 v252, 0xffff0000, v252
  v_accvgpr_write_b32 a164, v11
  v_accvgpr_write_b32 a165, v252
  v_lshlrev_b32 v11, 16, v253
  v_and_b32 v253, 0xffff0000, v253
  v_accvgpr_write_b32 a166, v11
  v_accvgpr_write_b32 a167, v253
  v_lshlrev_b32 v11, 16, v254
  v_and_b32 v254, 0xffff0000, v254
  v_accvgpr_write_b32 a168, v11
  v_accvgpr_write_b32 a169, v254
  v_lshlrev_b32 v11, 16, v255
  v_and_b32 v255, 0xffff0000, v255
  v_accvgpr_write_b32 a170, v11
  v_accvgpr_write_b32 a171, v255
  s_add_u32 s50, s3, 19
  s_sub_u32 s51, s3, 32
  s_cmp_lt_u32 s3, 32
  s_cselect_b32 s50, s50, s51
  s_cmp_eq_u32 s3, 64
  s_cselect_b32 s50, 51, s50
  s_lshl_b32 s50, s50, 2
  s_cmp_eq_u32 s18, 52
  s_cselect_b32 s50, s50, 1073741824
  v_mov_b32 v238, s50
  s_cmp_eq_u32 s18, 52
  s_cbranch_scc0 standalone__cross_network_dcn_v2__recsys_kernel_nat1
  s_waitcnt vmcnt(0)
  s_mov_b64 exec, 1
  buffer_store_dword v236, v238, s[44:47], 0 offen sc1
  s_mov_b64 exec, -1
standalone__cross_network_dcn_v2__recsys_kernel_nat1:
  s_add_u32 s28, s16, 140928
  s_addc_u32 s29, s17, 0
  s_mov_b32 s30, 1051392
  s_mov_b32 s19, 0
  s_mov_b32 s54, 59904
  s_mov_b32 s55, 129024
  s_waitcnt lgkmcnt(0)
  v_accvgpr_write_b32 a52, v220
  v_accvgpr_write_b32 a53, 0
  v_accvgpr_write_b32 a54, 0
  v_accvgpr_write_b32 a55, 0
  v_accvgpr_write_b32 a80, v221
  v_accvgpr_write_b32 a81, 0
  v_accvgpr_write_b32 a82, 0
  v_accvgpr_write_b32 a83, 0
  v_accvgpr_write_b32 a108, v222
  v_accvgpr_write_b32 a109, 0
  v_accvgpr_write_b32 a110, 0
  v_accvgpr_write_b32 a111, 0
  v_accvgpr_write_b32 a136, v223
  v_accvgpr_write_b32 a137, 0
  v_accvgpr_write_b32 a138, 0
  v_accvgpr_write_b32 a139, 0
  s_barrier
  ds_read_b128 a[0:3], v232 offset:0
  ds_read_b128 a[4:7], v232 offset:1024
  ds_read_b128 a[8:11], v232 offset:2048
  ds_read_b128 a[12:15], v232 offset:3072
  ds_read_b128 a[16:19], v232 offset:4096
  ds_read_b128 a[20:23], v232 offset:5120
  ds_read_b128 a[24:27], v232 offset:6144
  ds_read_b128 a[188:191], v8 offset:0
  ds_read_b128 a[192:195], v8 offset:13312
  ds_read_b128 a[196:199], v9 offset:0
  ds_read_b128 a[200:203], v9 offset:13312
  ds_read_b128 a[204:207], v8 offset:1024
  ds_read_b128 a[208:211], v8 offset:14336
  ds_read_b128 a[212:215], v9 offset:1024
  s_waitcnt lgkmcnt(6)
  v_mfma_f32_16x16x32_bf16 v[220:223], a[0:3], a[188:191], 0
  s_add_u32 m0, s55, 0
  s_nop 0
  buffer_load_dwordx4 v0, s[36:39], s54 offen lds
  ds_read_b128 a[216:219], v9 offset:14336
  s_waitcnt lgkmcnt(6)
  v_mfma_f32_16x16x32_bf16 v[228:231], a[0:3], a[192:195], 0
  buffer_load_dwordx4 v0, s[36:39], s54 offen offset:1024 lds
  ds_read_b128 a[188:191], v8 offset:2048
  s_waitcnt lgkmcnt(6)
  v_mfma_f32_16x16x32_bf16 v[224:227], a[0:3], a[196:199], 0
  buffer_load_dwordx4 v0, s[36:39], s54 offen offset:2048 lds
  ds_read_b128 a[192:195], v8 offset:15360
  s_waitcnt lgkmcnt(6)
  v_mfma_f32_16x16x32_bf16 v[232:235], a[0:3], a[200:203], 0
  buffer_load_dwordx4 v0, s[36:39], s54 offen offset:3072 lds
  ds_read_b128 a[196:199], v9 offset:2048
  s_waitcnt lgkmcnt(6)
  v_mfma_f32_16x16x32_bf16 v[220:223], a[4:7], a[204:207], v[220:223]
  s_add_u32 s54, s54, 4096
  s_add_u32 m0, s55, 4096
  s_nop 0
  buffer_load_dwordx4 v0, s[36:39], s54 offen lds
  ds_read_b128 a[200:203], v9 offset:15360
  s_waitcnt lgkmcnt(6)
  v_mfma_f32_16x16x32_bf16 v[228:231], a[4:7], a[208:211], v[228:231]
  buffer_load_dwordx4 v0, s[36:39], s54 offen offset:1024 lds
  ds_read_b128 a[204:207], v8 offset:3072
  s_waitcnt lgkmcnt(6)
  v_mfma_f32_16x16x32_bf16 v[224:227], a[4:7], a[212:215], v[224:227]
  buffer_load_dwordx4 v0, s[36:39], s54 offen offset:2048 lds
  ds_read_b128 a[208:211], v8 offset:16384
  s_waitcnt lgkmcnt(6)
  v_mfma_f32_16x16x32_bf16 v[232:235], a[4:7], a[216:219], v[232:235]
  buffer_load_dwordx4 v0, s[36:39], s54 offen offset:3072 lds
  ds_read_b128 a[212:215], v9 offset:3072
  s_waitcnt lgkmcnt(6)
  v_mfma_f32_16x16x32_bf16 v[220:223], a[8:11], a[188:191], v[220:223]
  s_add_u32 s54, s54, 4096
  s_add_u32 m0, s55, 8192
  s_nop 0
  buffer_load_dwordx4 v0, s[36:39], s54 offen lds
  ds_read_b128 a[216:219], v9 offset:16384
  s_waitcnt lgkmcnt(6)
  v_mfma_f32_16x16x32_bf16 v[228:231], a[8:11], a[192:195], v[228:231]
  buffer_load_dwordx4 v0, s[36:39], s54 offen offset:1024 lds
  ds_read_b128 a[188:191], v8 offset:4096
  s_waitcnt lgkmcnt(6)
  v_mfma_f32_16x16x32_bf16 v[224:227], a[8:11], a[196:199], v[224:227]
  buffer_load_dwordx4 v0, s[36:39], s54 offen offset:2048 lds
  ds_read_b128 a[192:195], v8 offset:17408
  s_waitcnt lgkmcnt(6)
  v_mfma_f32_16x16x32_bf16 v[232:235], a[8:11], a[200:203], v[232:235]
  buffer_load_dwordx4 v0, s[36:39], s54 offen offset:3072 lds
  ds_read_b128 a[196:199], v9 offset:4096
  s_waitcnt lgkmcnt(6)
  v_mfma_f32_16x16x32_bf16 v[220:223], a[12:15], a[204:207], v[220:223]
  s_add_u32 s54, s54, 4096
  s_add_u32 m0, s55, 12288
  s_nop 0
  buffer_load_dwordx4 v0, s[36:39], s54 offen lds
  ds_read_b128 a[200:203], v9 offset:17408
  s_waitcnt lgkmcnt(6)
  v_mfma_f32_16x16x32_bf16 v[228:231], a[12:15], a[208:211], v[228:231]
  buffer_load_dwordx4 v0, s[36:39], s54 offen offset:1024 lds
  ds_read_b128 a[204:207], v8 offset:5120
  s_waitcnt lgkmcnt(6)
  v_mfma_f32_16x16x32_bf16 v[224:227], a[12:15], a[212:215], v[224:227]
  buffer_load_dwordx4 v0, s[36:39], s54 offen offset:2048 lds
  ds_read_b128 a[208:211], v8 offset:18432
  s_waitcnt lgkmcnt(6)
  v_mfma_f32_16x16x32_bf16 v[232:235], a[12:15], a[216:219], v[232:235]
  buffer_load_dwordx4 v0, s[36:39], s54 offen offset:3072 lds
  ds_read_b128 a[212:215], v9 offset:5120
  s_waitcnt lgkmcnt(6)
  v_mfma_f32_16x16x32_bf16 v[220:223], a[16:19], a[188:191], v[220:223]
  s_add_u32 s54, s54, 4096
  s_add_u32 m0, s55, 16384
  s_nop 0
  buffer_load_dwordx4 v0, s[36:39], s54 offen lds
  ds_read_b128 a[216:219], v9 offset:18432
  s_waitcnt lgkmcnt(6)
  v_mfma_f32_16x16x32_bf16 v[228:231], a[16:19], a[192:195], v[228:231]
  buffer_load_dwordx4 v0, s[36:39], s54 offen offset:1024 lds
  ds_read_b128 a[188:191], v8 offset:6144
  s_barrier
  s_waitcnt lgkmcnt(6)
  v_mfma_f32_16x16x32_bf16 v[224:227], a[16:19], a[196:199], v[224:227]
  buffer_load_dwordx4 v0, s[36:39], s54 offen offset:2048 lds
  ds_read_b128 a[192:195], v8 offset:19456
  ds_read_b128 v[176:179], v6 offset:30720
  ds_read_b128 v[184:187], v7 offset:30720
  s_waitcnt lgkmcnt(8)
  v_mfma_f32_16x16x32_bf16 v[232:235], a[16:19], a[200:203], v[232:235]
  buffer_load_dwordx4 v0, s[36:39], s54 offen offset:3072 lds
  ds_read_b128 a[196:199], v8 offset:26624
  s_waitcnt lgkmcnt(8)
  v_mfma_f32_16x16x32_bf16 v[220:223], a[20:23], a[204:207], v[220:223]
  s_add_u32 s54, s54, 4096
  s_add_u32 m0, s55, 20480
  s_nop 0
  buffer_load_dwordx4 v0, s[36:39], s54 offen lds
  ds_read_b128 a[200:203], v8 offset:39936
  s_waitcnt lgkmcnt(3)
  v_mfma_f32_16x16x32_bf16 v[228:231], a[20:23], a[208:211], v[228:231]
  buffer_load_dwordx4 v0, s[36:39], s54 offen offset:1024 lds
  ds_read_b128 a[204:207], v9 offset:26624
  v_lshlrev_b32 v172, 16, v176
  v_and_b32 v173, 0xffff0000, v176
  v_lshlrev_b32 v174, 16, v177
  v_and_b32 v175, 0xffff0000, v177
  v_lshlrev_b32 v176, 16, v178
  v_and_b32 v177, 0xffff0000, v178
  v_mfma_f32_16x16x32_bf16 v[224:227], a[20:23], a[212:215], v[224:227]
  buffer_load_dwordx4 v0, s[36:39], s54 offen offset:2048 lds
  ds_read_b128 a[208:211], v9 offset:39936
  v_lshlrev_b32 v178, 16, v179
  v_and_b32 v179, 0xffff0000, v179
  s_waitcnt lgkmcnt(4)
  v_lshlrev_b32 v180, 16, v184
  v_and_b32 v181, 0xffff0000, v184
  v_lshlrev_b32 v182, 16, v185
  v_and_b32 v183, 0xffff0000, v185
  v_mfma_f32_16x16x32_bf16 v[232:235], a[20:23], a[216:219], v[232:235]
  buffer_load_dwordx4 v0, s[36:39], s54 offen offset:3072 lds
  ds_read_b128 a[212:215], v8 offset:27648
  v_lshlrev_b32 v184, 16, v186
  v_and_b32 v185, 0xffff0000, v186
  v_lshlrev_b32 v186, 16, v187
  v_and_b32 v187, 0xffff0000, v187
  ds_read_b128 v[248:251], v4 offset:31744
  ds_read_b128 v[252:255], v5 offset:31744
  v_mfma_f32_16x16x32_bf16 v[220:223], a[24:27], a[188:191], v[220:223]
  s_add_u32 s54, s54, 4096
  s_add_u32 m0, s55, 24576
  s_nop 0
  buffer_load_dwordx4 v0, s[36:39], s54 offen lds
  ds_read_b128 a[216:219], v8 offset:40960
  v_mfma_f32_16x16x32_bf16 v[228:231], a[24:27], a[192:195], v[228:231]
  buffer_load_dwordx4 v0, s[36:39], s54 offen offset:1024 lds
  ds_read_b128 a[188:191], v9 offset:27648
  v_add_f32 v220, v220, v226
  v_add_f32 v221, v221, v227
  v_cvt_pk_bf16_f32 v240, v220, v221
  s_nop 2
  v_add_f32 v228, v228, v234
  v_add_f32 v229, v229, v235
  v_cvt_pk_bf16_f32 v241, v228, v229
  s_waitcnt lgkmcnt(3)
  v_mfma_f32_16x16x32_bf16 v[220:223], a[0:3], a[196:199], 0
  ds_read_b128 a[192:195], v9 offset:40960
  v_lshlrev_b32 v11, 16, v248
  v_and_b32 v248, 0xffff0000, v248
  v_accvgpr_write_b32 a172, v11
  v_accvgpr_write_b32 a173, v248
  v_lshlrev_b32 v11, 16, v249
  v_and_b32 v249, 0xffff0000, v249
  v_accvgpr_write_b32 a174, v11
  v_mfma_f32_16x16x32_bf16 v[228:231], a[0:3], a[200:203], 0
  ds_read_b128 a[196:199], v8 offset:28672
  v_accvgpr_write_b32 a175, v249
  v_lshlrev_b32 v11, 16, v250
  v_and_b32 v250, 0xffff0000, v250
  v_accvgpr_write_b32 a176, v11
  v_accvgpr_write_b32 a177, v250
  v_lshlrev_b32 v11, 16, v251
  v_and_b32 v251, 0xffff0000, v251
  v_mfma_f32_16x16x32_bf16 v[224:227], a[0:3], a[204:207], 0
  ds_read_b128 a[200:203], v8 offset:41984
  v_accvgpr_write_b32 a178, v11
  v_accvgpr_write_b32 a179, v251
  s_waitcnt lgkmcnt(5)
  v_lshlrev_b32 v11, 16, v252
  v_and_b32 v252, 0xffff0000, v252
  v_accvgpr_write_b32 a180, v11
  v_accvgpr_write_b32 a181, v252
  v_lshlrev_b32 v11, 16, v253
  v_mfma_f32_16x16x32_bf16 v[232:235], a[0:3], a[208:211], 0
  ds_read_b128 a[204:207], v9 offset:28672
  v_and_b32 v253, 0xffff0000, v253
  v_accvgpr_write_b32 a182, v11
  v_accvgpr_write_b32 a183, v253
  v_lshlrev_b32 v11, 16, v254
  v_and_b32 v254, 0xffff0000, v254
  v_accvgpr_write_b32 a184, v11
  v_accvgpr_write_b32 a185, v254
  v_mfma_f32_16x16x32_bf16 v[220:223], a[4:7], a[212:215], v[220:223]
  ds_read_b128 a[208:211], v9 offset:41984
  v_lshlrev_b32 v11, 16, v255
  v_and_b32 v255, 0xffff0000, v255
  v_accvgpr_write_b32 a186, v11
  v_accvgpr_write_b32 a187, v255
  ds_read_b128 v[192:195], v6 offset:31744
  ds_read_b128 v[200:203], v7 offset:31744
  s_waitcnt lgkmcnt(8)
  v_mfma_f32_16x16x32_bf16 v[228:231], a[4:7], a[216:219], v[228:231]
  ds_read_b128 a[212:215], v8 offset:29696
  s_waitcnt lgkmcnt(8)
  v_mfma_f32_16x16x32_bf16 v[224:227], a[4:7], a[188:191], v[224:227]
  ds_read_b128 a[216:219], v8 offset:43008
  s_waitcnt lgkmcnt(3)
  v_mfma_f32_16x16x32_bf16 v[232:235], a[4:7], a[192:195], v[232:235]
  ds_read_b128 a[188:191], v9 offset:29696
  v_lshlrev_b32 v188, 16, v192
  v_and_b32 v189, 0xffff0000, v192
  v_lshlrev_b32 v190, 16, v193
  v_and_b32 v191, 0xffff0000, v193
  v_lshlrev_b32 v192, 16, v194
  v_and_b32 v193, 0xffff0000, v194
  v_lshlrev_b32 v194, 16, v195
  v_mfma_f32_16x16x32_bf16 v[220:223], a[8:11], a[196:199], v[220:223]
  ds_read_b128 a[192:195], v9 offset:43008
  v_and_b32 v195, 0xffff0000, v195
  s_waitcnt lgkmcnt(4)
  v_lshlrev_b32 v196, 16, v200
  v_and_b32 v197, 0xffff0000, v200
  v_lshlrev_b32 v198, 16, v201
  v_and_b32 v199, 0xffff0000, v201
  v_lshlrev_b32 v200, 16, v202
  v_and_b32 v201, 0xffff0000, v202
  v_mfma_f32_16x16x32_bf16 v[228:231], a[8:11], a[200:203], v[228:231]
  ds_read_b128 a[196:199], v8 offset:30720
  v_lshlrev_b32 v202, 16, v203
  v_and_b32 v203, 0xffff0000, v203
  ds_read_b128 v[208:211], v4 offset:32768
  ds_read_b128 v[216:219], v5 offset:32768
  v_mfma_f32_16x16x32_bf16 v[224:227], a[8:11], a[204:207], v[224:227]
  ds_read_b128 a[200:203], v8 offset:44032
  v_mfma_f32_16x16x32_bf16 v[232:235], a[8:11], a[208:211], v[232:235]
  ds_read_b128 a[204:207], v9 offset:30720
  s_waitcnt lgkmcnt(3)
  v_mfma_f32_16x16x32_bf16 v[220:223], a[12:15], a[212:215], v[220:223]
  ds_read_b128 a[208:211], v9 offset:44032
  v_lshlrev_b32 v204, 16, v208
  v_and_b32 v205, 0xffff0000, v208
  v_lshlrev_b32 v206, 16, v209
  v_and_b32 v207, 0xffff0000, v209
  v_lshlrev_b32 v208, 16, v210
  v_and_b32 v209, 0xffff0000, v210
  v_lshlrev_b32 v210, 16, v211
  v_mfma_f32_16x16x32_bf16 v[228:231], a[12:15], a[216:219], v[228:231]
  ds_read_b128 a[212:215], v8 offset:31744
  v_and_b32 v211, 0xffff0000, v211
  s_waitcnt lgkmcnt(4)
  v_lshlrev_b32 v212, 16, v216
  v_and_b32 v213, 0xffff0000, v216
  v_lshlrev_b32 v214, 16, v217
  v_and_b32 v215, 0xffff0000, v217
  v_lshlrev_b32 v216, 16, v218
  v_and_b32 v217, 0xffff0000, v218
  v_mfma_f32_16x16x32_bf16 v[224:227], a[12:15], a[188:191], v[224:227]
  ds_read_b128 a[216:219], v8 offset:45056
  v_lshlrev_b32 v218, 16, v219
  v_and_b32 v219, 0xffff0000, v219
  buffer_load_dword v239, off, s[44:47], 0 offset:252
  v_mfma_f32_16x16x32_bf16 v[232:235], a[12:15], a[192:195], v[232:235]
  ds_read_b128 a[188:191], v9 offset:31744
  v_mfma_f32_16x16x32_bf16 v[220:223], a[16:19], a[196:199], v[220:223]
  ds_read_b128 a[192:195], v9 offset:45056
  s_waitcnt lgkmcnt(6)
  v_mfma_f32_16x16x32_bf16 v[228:231], a[16:19], a[200:203], v[228:231]
  ds_read_b128 a[196:199], v8 offset:32768
  s_waitcnt lgkmcnt(6)
  v_mfma_f32_16x16x32_bf16 v[224:227], a[16:19], a[204:207], v[224:227]
  s_waitcnt vmcnt(7)
  ds_read_b128 a[28:31], v10 offset:0
  ds_read_b128 a[32:35], v10 offset:32
  ds_read_b128 a[36:39], v10 offset:64
  ds_read_b128 a[40:43], v10 offset:96
  ds_read_b128 a[44:47], v10 offset:128
  ds_read_b128 a[48:51], v10 offset:160
  s_mov_b32 exec_hi, 0
  ds_read_b128 a[52:55], v10 offset:192
  s_mov_b32 exec_hi, -1
  ds_read_b128 a[200:203], v8 offset:46080
  s_waitcnt lgkmcnt(13)
  v_mfma_f32_16x16x32_bf16 v[232:235], a[16:19], a[208:211], v[232:235]
  s_waitcnt lgkmcnt(12)
  v_mfma_f32_16x16x32_bf16 v[220:223], a[20:23], a[212:215], v[220:223]
  ds_read_b128 a[56:59], v10 offset:6656
  ds_read_b128 a[60:63], v10 offset:6688
  ds_read_b128 a[64:67], v10 offset:6720
  s_waitcnt lgkmcnt(14)
  ds_read_b128 a[68:71], v10 offset:6752
  s_waitcnt lgkmcnt(14)
  ds_read_b128 a[72:75], v10 offset:6784
  s_waitcnt lgkmcnt(14)
  ds_read_b128 a[76:79], v10 offset:6816
  s_mov_b32 exec_hi, 0
  s_waitcnt lgkmcnt(14)
  ds_read_b128 a[80:83], v10 offset:6848
  s_mov_b32 exec_hi, -1
  v_mfma_f32_16x16x32_bf16 v[228:231], a[20:23], a[216:219], v[228:231]
  v_mfma_f32_16x16x32_bf16 v[224:227], a[20:23], a[188:191], v[224:227]
  s_waitcnt lgkmcnt(14)
  ds_read_b128 a[84:87], v10 offset:13312
  s_waitcnt lgkmcnt(14)
  ds_read_b128 a[88:91], v10 offset:13344
  s_waitcnt lgkmcnt(14)
  ds_read_b128 a[92:95], v10 offset:13376
  s_waitcnt lgkmcnt(14)
  ds_read_b128 a[96:99], v10 offset:13408
  s_waitcnt lgkmcnt(14)
  ds_read_b128 a[100:103], v10 offset:13440
  s_waitcnt lgkmcnt(14)
  ds_read_b128 a[104:107], v10 offset:13472
  s_mov_b32 exec_hi, 0
  s_waitcnt lgkmcnt(14)
  ds_read_b128 a[108:111], v10 offset:13504
  s_mov_b32 exec_hi, -1
  v_mfma_f32_16x16x32_bf16 v[232:235], a[20:23], a[192:195], v[232:235]
  v_mfma_f32_16x16x32_bf16 v[220:223], a[24:27], a[196:199], v[220:223]
  s_waitcnt vmcnt(1) lgkmcnt(14)
  ds_read_b128 a[112:115], v10 offset:19968
  s_waitcnt lgkmcnt(14)
  ds_read_b128 a[116:119], v10 offset:20000
  s_waitcnt lgkmcnt(14)
  ds_read_b128 a[120:123], v10 offset:20032
  s_waitcnt lgkmcnt(14)
  ds_read_b128 a[124:127], v10 offset:20064
  s_waitcnt lgkmcnt(14)
  ds_read_b128 a[128:131], v10 offset:20096
  s_waitcnt lgkmcnt(14)
  ds_read_b128 a[132:135], v10 offset:20128
  s_mov_b32 exec_hi, 0
  s_waitcnt lgkmcnt(14)
  ds_read_b128 a[136:139], v10 offset:20160
  s_mov_b32 exec_hi, -1
  s_waitcnt lgkmcnt(14)
  ds_write_b128 v243, v[244:247]
  s_waitcnt lgkmcnt(14)
  ds_write_b32 v2, v240 offset:0
  s_waitcnt lgkmcnt(14)
  ds_write_b32 v2, v241 offset:256
  s_waitcnt vmcnt(0)
  v_cmp_le_u32 vcc, 13, v239
  s_mov_b32 s50, 0
  s_cbranch_vccnz standalone__cross_network_dcn_v2__recsys_kernel_pollAok
  s_cmp_eq_u32 s19, 2
  s_cbranch_scc1 standalone__cross_network_dcn_v2__recsys_kernel_pollAok
standalone__cross_network_dcn_v2__recsys_kernel_pollA:
  buffer_load_dword v239, off, s[44:47], 0 offset:252 sc1
  s_waitcnt vmcnt(0)
  v_cmp_le_u32 vcc, 13, v239
  s_add_u32 s50, s50, 1
  s_cbranch_vccnz standalone__cross_network_dcn_v2__recsys_kernel_pollAok
  s_cmp_lt_u32 s50, 4000
  s_cbranch_scc1 standalone__cross_network_dcn_v2__recsys_kernel_pollA
  s_mov_b32 s19, 0
  s_branch standalone__cross_network_dcn_v2__recsys_kernel_fb
standalone__cross_network_dcn_v2__recsys_kernel_pollAok:
  s_waitcnt lgkmcnt(0)
  s_barrier
  v_mfma_f32_16x16x32_bf16 v[228:231], a[24:27], a[200:203], v[228:231]
  v_add_u32 v10, 23552, v0
  ds_read_b128 a[220:223], v0 offset:0
  ds_read_b128 a[224:227], v0 offset:1024
  ds_read_b128 a[228:231], v0 offset:2048
  ds_read_b128 a[232:235], v0 offset:3072
  ds_read_b128 a[236:239], v0 offset:4096
  ds_read_b128 a[240:243], v0 offset:5120
standalone__cross_network_dcn_v2__recsys_kernel_loopR:
  s_waitcnt vmcnt(24) lgkmcnt(5)
  v_mfma_f32_32x32x16_bf16 v[12:27], a[28:31], a[220:223], v[12:27]
  s_add_u32 s28, s28, 175232
  s_addc_u32 s29, s29, 0
  s_sub_u32 s30, s30, 175232
  buffer_load_dwordx4 a[0:3], v0, s[28:31], 0 offen sc1
  ds_read_b128 a[244:247], v0 offset:6144
  v_add_f32 v220, v220, v226
  v_add_f32 v221, v221, v227
  v_cvt_pk_bf16_f32 v224, v220, v221
  ds_write_b32 v2, v224 offset:7168
  v_add_f32 v228, v228, v234
  v_add_f32 v229, v229, v235
  v_cvt_pk_bf16_f32 v232, v228, v229
  ds_write_b32 v2, v232 offset:7424
  s_waitcnt lgkmcnt(7)
  v_mfma_f32_32x32x16_bf16 v[12:27], a[32:35], a[224:227], v[12:27]
  s_waitcnt lgkmcnt(6)
  v_mfma_f32_32x32x16_bf16 v[12:27], a[36:39], a[228:231], v[12:27]
  buffer_load_dwordx4 a[4:7], v0, s[28:31], 0 offen offset:1024 sc1
  s_waitcnt lgkmcnt(5)
  v_mfma_f32_32x32x16_bf16 v[12:27], a[40:43], a[232:235], v[12:27]
  s_waitcnt vmcnt(22) lgkmcnt(4)
  v_mfma_f32_32x32x16_bf16 v[12:27], a[44:47], a[236:239], v[12:27]
  s_waitcnt lgkmcnt(3)
  v_mfma_f32_32x32x16_bf16 v[12:27], a[48:51], a[240:243], v[12:27]
  buffer_load_dwordx4 a[8:11], v0, s[28:31], 0 offen offset:2048 sc1
  s_waitcnt lgkmcnt(2)
  v_mfma_f32_32x32x16_bf16 v[12:27], a[52:55], a[244:247], v[12:27]
  v_mfma_f32_32x32x16_bf16 v[28:43], a[56:59], a[220:223], v[28:43]
  s_waitcnt vmcnt(19)
  v_mfma_f32_32x32x16_bf16 v[28:43], a[60:63], a[224:227], v[28:43]
  buffer_load_dwordx4 a[12:15], v0, s[28:31], 0 offen offset:3072 sc1
  s_nop 8
  v_mul_f32 v244, v140, v12
  v_mul_f32 v245, v141, v13
  v_cvt_pk_bf16_f32 v236, v244, v245
  v_mul_f32 v246, v142, v14
  v_mfma_f32_32x32x16_bf16 v[28:43], a[64:67], a[228:231], v[28:43]
  v_mul_f32 v247, v143, v15
  v_cvt_pk_bf16_f32 v237, v246, v247
  v_mul_f32 v244, v144, v16
  v_mul_f32 v245, v145, v17
  v_cvt_pk_bf16_f32 v238, v244, v245
  v_mfma_f32_32x32x16_bf16 v[28:43], a[68:71], a[232:235], v[28:43]
  buffer_load_dwordx4 a[16:19], v0, s[28:31], s60 offen sc1
  v_mul_f32 v246, v146, v18
  v_mul_f32 v247, v147, v19
  v_cvt_pk_bf16_f32 v239, v246, v247
  v_mul_f32 v244, v148, v20
  v_mfma_f32_32x32x16_bf16 v[28:43], a[72:75], a[236:239], v[28:43]
  ds_write_b128 v6, v[236:239] offset:4096
  v_mul_f32 v245, v149, v21
  s_waitcnt vmcnt(17)
  v_mfma_f32_32x32x16_bf16 v[28:43], a[76:79], a[240:243], v[28:43]
  v_cvt_pk_bf16_f32 v240, v244, v245
  v_mul_f32 v246, v150, v22
  v_mul_f32 v247, v151, v23
  v_cvt_pk_bf16_f32 v241, v246, v247
  v_mul_f32 v244, v152, v24
  v_mfma_f32_32x32x16_bf16 v[28:43], a[80:83], a[244:247], v[28:43]
  buffer_load_dwordx4 a[20:23], v0, s[28:31], s60 offen offset:1024 sc1
  v_mul_f32 v245, v153, v25
  v_cvt_pk_bf16_f32 v242, v244, v245
  v_mul_f32 v246, v154, v26
  v_mul_f32 v247, v155, v27
  v_mfma_f32_32x32x16_bf16 v[44:59], a[84:87], a[220:223], v[44:59]
  v_cvt_pk_bf16_f32 v243, v246, v247
  ds_write_b128 v7, v[240:243] offset:4096
  v_mfma_f32_32x32x16_bf16 v[44:59], a[88:91], a[224:227], v[44:59]
  v_accvgpr_read_b32 v244, a140
  v_accvgpr_read_b32 v245, a141
  s_nop 0
  v_mul_f32 v244, v244, v28
  v_mul_f32 v245, v245, v29
  v_cvt_pk_bf16_f32 v236, v244, v245
  s_waitcnt vmcnt(14)
  v_mfma_f32_32x32x16_bf16 v[44:59], a[92:95], a[228:231], v[44:59]
  buffer_load_dwordx4 a[24:27], v0, s[28:31], s60 offen offset:2048 sc1
  v_accvgpr_read_b32 v246, a142
  v_accvgpr_read_b32 v247, a143
  v_mul_f32 v246, v246, v30
  v_mul_f32 v247, v247, v31
  v_mfma_f32_32x32x16_bf16 v[44:59], a[96:99], a[232:235], v[44:59]
  v_cvt_pk_bf16_f32 v237, v246, v247
  v_accvgpr_read_b32 v244, a144
  v_accvgpr_read_b32 v245, a145
  v_mul_f32 v244, v244, v32
  v_mul_f32 v245, v245, v33
  v_mfma_f32_32x32x16_bf16 v[44:59], a[100:103], a[236:239], v[44:59]
  v_cvt_pk_bf16_f32 v238, v244, v245
  v_accvgpr_read_b32 v246, a146
  v_accvgpr_read_b32 v247, a147
  v_mul_f32 v246, v246, v34
  v_mul_f32 v247, v247, v35
  v_mfma_f32_32x32x16_bf16 v[44:59], a[104:107], a[240:243], v[44:59]
  v_cvt_pk_bf16_f32 v239, v246, v247
  ds_write_b128 v4, v[236:239] offset:5120
  s_waitcnt vmcnt(11)
  v_mfma_f32_32x32x16_bf16 v[44:59], a[108:111], a[244:247], v[44:59]
  v_accvgpr_read_b32 v244, a148
  v_accvgpr_read_b32 v245, a149
  v_mul_f32 v244, v244, v36
  v_mul_f32 v245, v245, v37
  v_cvt_pk_bf16_f32 v240, v244, v245
  s_waitcnt lgkmcnt(3)
  s_barrier
  v_mfma_f32_32x32x16_bf16 v[60:75], a[112:115], a[220:223], v[60:75]
  ds_read_b128 a[220:223], v0 offset:7168
  v_accvgpr_read_b32 v246, a150
  v_accvgpr_read_b32 v247, a151
  v_mul_f32 v246, v246, v38
  v_mul_f32 v247, v247, v39
  v_mfma_f32_32x32x16_bf16 v[60:75], a[116:119], a[224:227], v[60:75]
  ds_read_b128 a[224:227], v0 offset:8192
  v_cvt_pk_bf16_f32 v241, v246, v247
  v_accvgpr_read_b32 v244, a152
  v_accvgpr_read_b32 v245, a153
  v_mul_f32 v244, v244, v40
  v_mfma_f32_32x32x16_bf16 v[60:75], a[120:123], a[228:231], v[60:75]
  ds_read_b128 a[228:231], v0 offset:9216
  v_mul_f32 v245, v245, v41
  v_cvt_pk_bf16_f32 v242, v244, v245
  v_accvgpr_read_b32 v246, a154
  v_accvgpr_read_b32 v247, a155
  s_waitcnt vmcnt(7)
  v_mfma_f32_32x32x16_bf16 v[60:75], a[124:127], a[232:235], v[60:75]
  ds_read_b128 a[232:235], v0 offset:10240
  v_mul_f32 v246, v246, v42
  v_mul_f32 v247, v247, v43
  v_cvt_pk_bf16_f32 v243, v246, v247
  v_accvgpr_read_b32 v244, a156
  v_mfma_f32_32x32x16_bf16 v[60:75], a[128:131], a[236:239], v[60:75]
  ds_read_b128 a[236:239], v0 offset:11264
  ds_write_b128 v5, v[240:243] offset:5120
  v_mfma_f32_32x32x16_bf16 v[60:75], a[132:135], a[240:243], v[60:75]
  ds_read_b128 a[240:243], v0 offset:12288
  v_accvgpr_read_b32 v245, a157
  v_mul_f32 v244, v244, v44
  v_mul_f32 v245, v245, v45
  v_cvt_pk_bf16_f32 v236, v244, v245
  v_mfma_f32_32x32x16_bf16 v[60:75], a[136:139], a[244:247], v[60:75]
  ds_read_b128 a[244:247], v0 offset:13312
  v_accvgpr_read_b32 v246, a158
  v_accvgpr_read_b32 v247, a159
  v_mul_f32 v246, v246, v46
  v_mul_f32 v247, v247, v47
  s_waitcnt lgkmcnt(7)
  v_mfma_f32_32x32x16_bf16 v[76:91], a[28:31], a[220:223], v[76:91]
  buffer_load_dwordx4 a[28:31], v0, s[28:31], s60 offen offset:3072 sc1
  v_cvt_pk_bf16_f32 v237, v246, v247
  v_accvgpr_read_b32 v244, a160
  v_accvgpr_read_b32 v245, a161
  v_mul_f32 v244, v244, v48
  s_waitcnt lgkmcnt(6)
  v_mfma_f32_32x32x16_bf16 v[76:91], a[32:35], a[224:227], v[76:91]
  buffer_load_dwordx4 a[32:35], v0, s[28:31], s61 offen sc1
  v_mul_f32 v245, v245, v49
  v_cvt_pk_bf16_f32 v238, v244, v245
  v_accvgpr_read_b32 v246, a162
  v_accvgpr_read_b32 v247, a163
  s_waitcnt lgkmcnt(5)
  v_mfma_f32_32x32x16_bf16 v[76:91], a[36:39], a[228:231], v[76:91]
  buffer_load_dwordx4 a[36:39], v0, s[28:31], s61 offen offset:1024 sc1
  v_mul_f32 v246, v246, v50
  v_mul_f32 v247, v247, v51
  v_cvt_pk_bf16_f32 v239, v246, v247
  v_accvgpr_read_b32 v244, a164
  s_waitcnt lgkmcnt(4)
  v_mfma_f32_32x32x16_bf16 v[76:91], a[40:43], a[232:235], v[76:91]
  buffer_load_dwordx4 a[40:43], v0, s[28:31], s61 offen offset:2048 sc1
  ds_write_b128 v6, v[236:239] offset:5120
  s_waitcnt lgkmcnt(4)
  v_mfma_f32_32x32x16_bf16 v[76:91], a[44:47], a[236:239], v[76:91]
  buffer_load_dwordx4 a[44:47], v0, s[28:31], s61 offen offset:3072 sc1
  v_accvgpr_read_b32 v245, a165
  v_mul_f32 v244, v244, v52
  v_mul_f32 v245, v245, v53
  v_cvt_pk_bf16_f32 v240, v244, v245
  s_waitcnt lgkmcnt(2)
  v_mfma_f32_32x32x16_bf16 v[76:91], a[48:51], a[240:243], v[76:91]
  buffer_load_dwordx4 a[48:51], v0, s[28:31], s62 offen sc1
  v_accvgpr_read_b32 v246, a166
  v_accvgpr_read_b32 v247, a167
  v_mul_f32 v246, v246, v54
  v_mul_f32 v247, v247, v55
  s_waitcnt lgkmcnt(1)
  v_mfma_f32_32x32x16_bf16 v[76:91], a[52:55], a[244:247], v[76:91]
  buffer_load_dwordx4 a[52:55], v1, s[28:31], s62 offen offset:1024 sc1
  v_cvt_pk_bf16_f32 v241, v246, v247
  v_accvgpr_read_b32 v244, a168
  v_accvgpr_read_b32 v245, a169
  v_mul_f32 v244, v244, v56
  v_mfma_f32_32x32x16_bf16 v[92:107], a[56:59], a[220:223], v[92:107]
  v_mul_f32 v245, v245, v57
  v_cvt_pk_bf16_f32 v242, v244, v245
  v_accvgpr_read_b32 v246, a170
  v_accvgpr_read_b32 v247, a171
  v_mul_f32 v246, v246, v58
  v_mfma_f32_32x32x16_bf16 v[92:107], a[60:63], a[224:227], v[92:107]
  v_mul_f32 v247, v247, v59
  v_cvt_pk_bf16_f32 v243, v246, v247
  v_mul_f32 v244, v156, v60
  v_mul_f32 v245, v157, v61
  v_cvt_pk_bf16_f32 v236, v244, v245
  v_mfma_f32_32x32x16_bf16 v[92:107], a[64:67], a[228:231], v[92:107]
  buffer_load_dwordx4 a[56:59], v0, s[28:31], s62 offen offset:1664 sc1
  ds_write_b128 v7, v[240:243] offset:5120
  v_mfma_f32_32x32x16_bf16 v[92:107], a[68:71], a[232:235], v[92:107]
  v_mul_f32 v246, v158, v62
  v_mul_f32 v247, v159, v63
  v_cvt_pk_bf16_f32 v237, v246, v247
  v_mul_f32 v244, v160, v64
  v_mul_f32 v245, v161, v65
  v_mfma_f32_32x32x16_bf16 v[92:107], a[72:75], a[236:239], v[92:107]
  v_cvt_pk_bf16_f32 v238, v244, v245
  v_mul_f32 v246, v162, v66
  v_mul_f32 v247, v163, v67
  v_cvt_pk_bf16_f32 v239, v246, v247
  v_mul_f32 v244, v164, v68
  v_mfma_f32_32x32x16_bf16 v[92:107], a[76:79], a[240:243], v[92:107]
  buffer_load_dwordx4 a[60:63], v0, s[28:31], s62 offen offset:2688 sc1
  ds_write_b128 v4, v[236:239] offset:6144
  v_mfma_f32_32x32x16_bf16 v[92:107], a[80:83], a[244:247], v[92:107]
  v_mul_f32 v245, v165, v69
  v_cvt_pk_bf16_f32 v240, v244, v245
  v_mul_f32 v246, v166, v70
  v_mul_f32 v247, v167, v71
  v_cvt_pk_bf16_f32 v241, v246, v247
  v_mfma_f32_32x32x16_bf16 v[108:123], a[84:87], a[220:223], v[108:123]
  buffer_load_dwordx4 a[64:67], v0, s[28:31], s62 offen offset:3712 sc1
  v_mul_f32 v244, v168, v72
  v_mul_f32 v245, v169, v73
  v_cvt_pk_bf16_f32 v242, v244, v245
  v_mul_f32 v246, v170, v74
  v_mfma_f32_32x32x16_bf16 v[108:123], a[88:91], a[224:227], v[108:123]
  v_mul_f32 v247, v171, v75
  v_cvt_pk_bf16_f32 v243, v246, v247
  v_mul_f32 v244, v172, v76
  v_mul_f32 v245, v173, v77
  v_cvt_pk_bf16_f32 v236, v244, v245
  v_mfma_f32_32x32x16_bf16 v[108:123], a[92:95], a[228:231], v[108:123]
  ds_write_b128 v5, v[240:243] offset:6144
  v_mul_f32 v246, v174, v78
  v_mfma_f32_32x32x16_bf16 v[108:123], a[96:99], a[232:235], v[108:123]
  buffer_load_dwordx4 a[68:71], v0, s[28:31], s63 offen offset:640 sc1
  v_mul_f32 v247, v175, v79
  v_cvt_pk_bf16_f32 v237, v246, v247
  v_mul_f32 v244, v176, v80
  v_mul_f32 v245, v177, v81
  v_mfma_f32_32x32x16_bf16 v[108:123], a[100:103], a[236:239], v[108:123]
  v_cvt_pk_bf16_f32 v238, v244, v245
  v_mul_f32 v246, v178, v82
  v_mul_f32 v247, v179, v83
  v_cvt_pk_bf16_f32 v239, v246, v247
  v_mul_f32 v244, v180, v84
  v_mfma_f32_32x32x16_bf16 v[108:123], a[104:107], a[240:243], v[108:123]
  ds_write_b128 v6, v[236:239] offset:30720
  v_mul_f32 v245, v181, v85
  s_waitcnt lgkmcnt(1)
  s_barrier
  s_cmp_eq_u32 s19, 2
  s_cbranch_scc0 standalone__cross_network_dcn_v2__recsys_kernel_lookB
standalone__cross_network_dcn_v2__recsys_kernel_lookBret:
  v_mfma_f32_32x32x16_bf16 v[108:123], a[108:111], a[244:247], v[108:123]
  buffer_load_dwordx4 a[72:75], v0, s[28:31], s63 offen offset:1664 sc1
  v_cvt_pk_bf16_f32 v240, v244, v245
  v_mul_f32 v246, v182, v86
  v_mul_f32 v247, v183, v87
  v_cvt_pk_bf16_f32 v241, v246, v247
  v_mfma_f32_32x32x16_bf16 v[124:139], a[112:115], a[220:223], v[124:139]
  ds_read_b128 a[188:191], v8 offset:0
  v_mul_f32 v244, v184, v88
  v_mul_f32 v245, v185, v89
  v_cvt_pk_bf16_f32 v242, v244, v245
  v_mul_f32 v246, v186, v90
  v_mfma_f32_32x32x16_bf16 v[124:139], a[116:119], a[224:227], v[124:139]
  ds_read_b128 a[192:195], v8 offset:13312
  v_mul_f32 v247, v187, v91
  v_cvt_pk_bf16_f32 v243, v246, v247
  v_accvgpr_read_b32 v244, a172
  v_accvgpr_read_b32 v245, a173
  v_mfma_f32_32x32x16_bf16 v[124:139], a[120:123], a[228:231], v[124:139]
  buffer_load_dwordx4 a[76:79], v0, s[28:31], s63 offen offset:2688 sc1
  ds_read_b128 a[196:199], v9 offset:0
  v_mul_f32 v244, v244, v92
  v_mul_f32 v245, v245, v93
  v_cvt_pk_bf16_f32 v236, v244, v245
  v_mfma_f32_32x32x16_bf16 v[124:139], a[124:127], a[232:235], v[124:139]
  ds_read_b128 a[200:203], v9 offset:13312
  ds_write_b128 v7, v[240:243] offset:30720
  v_mfma_f32_32x32x16_bf16 v[124:139], a[128:131], a[236:239], v[124:139]
  buffer_load_dwordx4 a[80:83], v1, s[28:31], s63 offen offset:3712 sc1
  ds_read_b128 a[204:207], v8 offset:1024
  v_accvgpr_read_b32 v246, a174
  v_accvgpr_read_b32 v247, a175
  v_mul_f32 v246, v246, v94
  v_mfma_f32_32x32x16_bf16 v[124:139], a[132:135], a[240:243], v[124:139]
  ds_read_b128 a[208:211], v8 offset:14336
  v_mul_f32 v247, v247, v95
  v_cvt_pk_bf16_f32 v237, v246, v247
  v_accvgpr_read_b32 v244, a176
  v_accvgpr_read_b32 v245, a177
  v_mfma_f32_32x32x16_bf16 v[124:139], a[136:139], a[244:247], v[124:139]
  ds_read_b128 a[212:215], v9 offset:1024
  v_mul_f32 v244, v244, v96
  v_mul_f32 v245, v245, v97
  v_cvt_pk_bf16_f32 v238, v244, v245
  v_accvgpr_read_b32 v246, a178
  s_waitcnt vmcnt(20) lgkmcnt(7)
  v_mfma_f32_16x16x32_bf16 v[220:223], a[0:3], a[188:191], 0
  buffer_load_dwordx4 a[84:87], v0, s[28:31], s64 offen offset:256 sc1
  ds_read_b128 a[216:219], v9 offset:14336
  v_accvgpr_read_b32 v247, a179
  v_mul_f32 v246, v246, v98
  v_mul_f32 v247, v247, v99
  v_cvt_pk_bf16_f32 v239, v246, v247
  ds_write_b128 v4, v[236:239] offset:31744
  v_accvgpr_read_b32 v244, a180
  v_accvgpr_read_b32 v245, a181
  s_waitcnt lgkmcnt(8)
  v_mfma_f32_16x16x32_bf16 v[228:231], a[0:3], a[192:195], 0
  ds_read_b128 a[188:191], v8 offset:2048
  v_mul_f32 v244, v244, v100
  v_mul_f32 v245, v245, v101
  v_cvt_pk_bf16_f32 v240, v244, v245
  v_accvgpr_read_b32 v246, a182
  v_accvgpr_read_b32 v247, a183
  v_mul_f32 v246, v246, v102
  v_mul_f32 v247, v247, v103
  v_cvt_pk_bf16_f32 v241, v246, v247
  v_accvgpr_read_b32 v244, a184
  v_accvgpr_read_b32 v245, a185
  v_mul_f32 v244, v244, v104
  s_waitcnt lgkmcnt(8)
  v_mfma_f32_16x16x32_bf16 v[224:227], a[0:3], a[196:199], 0
  ds_read_b128 a[192:195], v8 offset:15360
  v_mul_f32 v245, v245, v105
  v_cvt_pk_bf16_f32 v242, v244, v245
  v_accvgpr_read_b32 v246, a186
  v_accvgpr_read_b32 v247, a187
  v_mul_f32 v246, v246, v106
  v_mul_f32 v247, v247, v107
  v_cvt_pk_bf16_f32 v243, v246, v247
  ds_write_b128 v5, v[240:243] offset:31744
  s_waitcnt lgkmcnt(9)
  v_mfma_f32_16x16x32_bf16 v[232:235], a[0:3], a[200:203], 0
  ds_read_b128 a[196:199], v9 offset:2048
  v_mul_f32 v244, v188, v108
  v_mul_f32 v245, v189, v109
  v_cvt_pk_bf16_f32 v236, v244, v245
  v_mul_f32 v246, v190, v110
  v_mul_f32 v247, v191, v111
  v_cvt_pk_bf16_f32 v237, v246, v247
  v_mul_f32 v244, v192, v112
  v_mul_f32 v245, v193, v113
  v_cvt_pk_bf16_f32 v238, v244, v245
  v_mul_f32 v246, v194, v114
  v_mul_f32 v247, v195, v115
  s_waitcnt vmcnt(20) lgkmcnt(8)
  v_mfma_f32_16x16x32_bf16 v[220:223], a[4:7], a[204:207], v[220:223]
  ds_read_b128 a[200:203], v9 offset:15360
  v_cvt_pk_bf16_f32 v239, v246, v247
  ds_write_b128 v6, v[236:239] offset:31744
  v_mul_f32 v244, v196, v116
  v_mul_f32 v245, v197, v117
  v_cvt_pk_bf16_f32 v240, v244, v245
  v_mul_f32 v246, v198, v118
  v_mul_f32 v247, v199, v119
  v_cvt_pk_bf16_f32 v241, v246, v247
  s_waitcnt lgkmcnt(9)
  v_mfma_f32_16x16x32_bf16 v[228:231], a[4:7], a[208:211], v[228:231]
  ds_read_b128 a[204:207], v8 offset:3072
  v_mul_f32 v244, v200, v120
  v_mul_f32 v245, v201, v121
  v_cvt_pk_bf16_f32 v242, v244, v245
  v_mul_f32 v246, v202, v122
  v_mul_f32 v247, v203, v123
  v_cvt_pk_bf16_f32 v243, v246, v247
  ds_write_b128 v7, v[240:243] offset:31744
  v_mul_f32 v244, v204, v124
  s_waitcnt lgkmcnt(10)
  v_mfma_f32_16x16x32_bf16 v[224:227], a[4:7], a[212:215], v[224:227]
  buffer_load_dwordx4 a[88:91], v0, s[28:31], s64 offen offset:1280 sc1
  ds_read_b128 a[208:211], v8 offset:16384
  v_mul_f32 v245, v205, v125
  v_cvt_pk_bf16_f32 v236, v244, v245
  v_mul_f32 v246, v206, v126
  v_mul_f32 v247, v207, v127
  v_cvt_pk_bf16_f32 v237, v246, v247
  v_mul_f32 v244, v208, v128
  v_mul_f32 v245, v209, v129
  v_cvt_pk_bf16_f32 v238, v244, v245
  v_mul_f32 v246, v210, v130
  v_mul_f32 v247, v211, v131
  s_waitcnt lgkmcnt(10)
  v_mfma_f32_16x16x32_bf16 v[232:235], a[4:7], a[216:219], v[232:235]
  ds_read_b128 a[212:215], v9 offset:3072
  v_cvt_pk_bf16_f32 v239, v246, v247
  ds_write_b128 v4, v[236:239] offset:32768
  v_mul_f32 v244, v212, v132
  v_mul_f32 v245, v213, v133
  v_cvt_pk_bf16_f32 v240, v244, v245
  v_mul_f32 v246, v214, v134
  v_mul_f32 v247, v215, v135
  v_cvt_pk_bf16_f32 v241, v246, v247
  s_waitcnt vmcnt(20) lgkmcnt(10)
  v_mfma_f32_16x16x32_bf16 v[220:223], a[8:11], a[188:191], v[220:223]
  ds_read_b128 a[216:219], v9 offset:16384
  v_mul_f32 v244, v216, v136
  v_mul_f32 v245, v217, v137
  v_cvt_pk_bf16_f32 v242, v244, v245
  v_mul_f32 v246, v218, v138
  v_mul_f32 v247, v219, v139
  v_cvt_pk_bf16_f32 v243, v246, v247
  ds_write_b128 v5, v[240:243] offset:32768
  s_waitcnt lgkmcnt(11)
  v_mfma_f32_16x16x32_bf16 v[228:231], a[8:11], a[192:195], v[228:231]
  ds_read_b128 a[188:191], v8 offset:4096
  s_waitcnt lgkmcnt(10)
  v_mfma_f32_16x16x32_bf16 v[224:227], a[8:11], a[196:199], v[224:227]
  ds_read_b128 a[192:195], v8 offset:17408
  s_waitcnt lgkmcnt(10)
  v_mfma_f32_16x16x32_bf16 v[232:235], a[8:11], a[200:203], v[232:235]
  buffer_load_dwordx4 a[92:95], v0, s[28:31], s64 offen offset:2304 sc1
  ds_read_b128 a[196:199], v9 offset:4096
  s_waitcnt vmcnt(20) lgkmcnt(9)
  v_mfma_f32_16x16x32_bf16 v[220:223], a[12:15], a[204:207], v[220:223]
  ds_read_b128 a[200:203], v9 offset:17408
  s_waitcnt lgkmcnt(8)
  v_mfma_f32_16x16x32_bf16 v[228:231], a[12:15], a[208:211], v[228:231]
  ds_read_b128 a[204:207], v8 offset:5120
  s_waitcnt lgkmcnt(8)
  v_mfma_f32_16x16x32_bf16 v[224:227], a[12:15], a[212:215], v[224:227]
  ds_read_b128 a[208:211], v8 offset:18432
  s_waitcnt lgkmcnt(7)
  v_mfma_f32_16x16x32_bf16 v[232:235], a[12:15], a[216:219], v[232:235]
  ds_read_b128 a[212:215], v9 offset:5120
  s_waitcnt vmcnt(19) lgkmcnt(6)
  v_mfma_f32_16x16x32_bf16 v[220:223], a[16:19], a[188:191], v[220:223]
  buffer_load_dwordx4 a[96:99], v0, s[28:31], s64 offen offset:3328 sc1
  ds_read_b128 a[216:219], v9 offset:18432
  s_waitcnt lgkmcnt(6)
  v_mfma_f32_16x16x32_bf16 v[228:231], a[16:19], a[192:195], v[228:231]
  ds_read_b128 a[188:191], v8 offset:6144
  s_barrier
  s_waitcnt lgkmcnt(6)
  v_mfma_f32_16x16x32_bf16 v[224:227], a[16:19], a[196:199], v[224:227]
  ds_read_b128 a[192:195], v8 offset:19456
  s_waitcnt lgkmcnt(6)
  v_mfma_f32_16x16x32_bf16 v[232:235], a[16:19], a[200:203], v[232:235]
  ds_read_b128 a[196:199], v8 offset:26624
  s_waitcnt vmcnt(19) lgkmcnt(6)
  v_mfma_f32_16x16x32_bf16 v[220:223], a[20:23], a[204:207], v[220:223]
  ds_read_b128 a[200:203], v8 offset:39936
  s_waitcnt lgkmcnt(6)
  v_mfma_f32_16x16x32_bf16 v[228:231], a[20:23], a[208:211], v[228:231]
  ds_read_b128 a[204:207], v9 offset:26624
  s_waitcnt lgkmcnt(6)
  v_mfma_f32_16x16x32_bf16 v[224:227], a[20:23], a[212:215], v[224:227]
  buffer_load_dwordx4 a[100:103], v0, s[28:31], s65 offen offset:256 sc1
  ds_read_b128 a[208:211], v9 offset:39936
  s_waitcnt lgkmcnt(6)
  v_mfma_f32_16x16x32_bf16 v[232:235], a[20:23], a[216:219], v[232:235]
  ds_read_b128 a[212:215], v8 offset:27648
  s_waitcnt vmcnt(19) lgkmcnt(6)
  v_mfma_f32_16x16x32_bf16 v[220:223], a[24:27], a[188:191], v[220:223]
  ds_read_b128 a[216:219], v8 offset:40960
  s_waitcnt lgkmcnt(6)
  v_mfma_f32_16x16x32_bf16 v[228:231], a[24:27], a[192:195], v[228:231]
  buffer_load_dwordx4 a[104:107], v0, s[28:31], s65 offen offset:1280 sc1
  buffer_load_dwordx4 a[108:111], v1, s[28:31], s65 offen offset:2304 sc1
  ds_read_b128 a[188:191], v9 offset:27648
  s_nop 1
  v_add_f32 v220, v220, v226
  v_add_f32 v221, v221, v227
  v_cvt_pk_bf16_f32 v224, v220, v221
  ds_write_b32 v2, v224 offset:0
  v_add_f32 v228, v228, v234
  v_add_f32 v229, v229, v235
  v_cvt_pk_bf16_f32 v232, v228, v229
  ds_write_b32 v2, v232 offset:256
  s_waitcnt lgkmcnt(8)
  v_mfma_f32_16x16x32_bf16 v[220:223], a[0:3], a[196:199], 0
  ds_read_b128 a[192:195], v9 offset:40960
  s_waitcnt lgkmcnt(8)
  v_mfma_f32_16x16x32_bf16 v[228:231], a[0:3], a[200:203], 0
  ds_read_b128 a[196:199], v8 offset:28672
  s_waitcnt lgkmcnt(8)
  v_mfma_f32_16x16x32_bf16 v[224:227], a[0:3], a[204:207], 0
  ds_read_b128 a[200:203], v8 offset:41984
  s_waitcnt lgkmcnt(8)
  v_mfma_f32_16x16x32_bf16 v[232:235], a[0:3], a[208:211], 0
  ds_read_b128 a[204:207], v9 offset:28672
  s_waitcnt lgkmcnt(8)
  v_mfma_f32_16x16x32_bf16 v[220:223], a[4:7], a[212:215], v[220:223]
  buffer_load_dwordx4 a[112:115], v0, s[28:31], s65 offen offset:2944 sc1
  ds_read_b128 a[208:211], v9 offset:41984
  s_waitcnt lgkmcnt(8)
  v_mfma_f32_16x16x32_bf16 v[228:231], a[4:7], a[216:219], v[228:231]
  ds_read_b128 a[212:215], v8 offset:29696
  s_waitcnt lgkmcnt(8)
  v_mfma_f32_16x16x32_bf16 v[224:227], a[4:7], a[188:191], v[224:227]
  ds_read_b128 a[216:219], v8 offset:43008
  s_waitcnt lgkmcnt(6)
  v_mfma_f32_16x16x32_bf16 v[232:235], a[4:7], a[192:195], v[232:235]
  ds_read_b128 a[188:191], v9 offset:29696
  s_waitcnt lgkmcnt(6)
  v_mfma_f32_16x16x32_bf16 v[220:223], a[8:11], a[196:199], v[220:223]
  ds_read_b128 a[192:195], v9 offset:43008
  s_waitcnt lgkmcnt(6)
  v_mfma_f32_16x16x32_bf16 v[228:231], a[8:11], a[200:203], v[228:231]
  ds_read_b128 a[196:199], v8 offset:30720
  s_waitcnt lgkmcnt(6)
  v_mfma_f32_16x16x32_bf16 v[224:227], a[8:11], a[204:207], v[224:227]
  buffer_load_dwordx4 a[116:119], v0, s[28:31], s65 offen offset:3968 sc1
  ds_read_b128 a[200:203], v8 offset:44032
  s_waitcnt lgkmcnt(6)
  v_mfma_f32_16x16x32_bf16 v[232:235], a[8:11], a[208:211], v[232:235]
  ds_read_b128 a[204:207], v9 offset:30720
  s_cmp_eq_u32 s19, 2
  s_cbranch_scc0 standalone__cross_network_dcn_v2__recsys_kernel_pollB
standalone__cross_network_dcn_v2__recsys_kernel_pollBret:
  s_waitcnt lgkmcnt(6)
  v_mfma_f32_16x16x32_bf16 v[220:223], a[12:15], a[212:215], v[220:223]
  ds_read_b128 a[208:211], v9 offset:44032
  s_barrier
  s_waitcnt lgkmcnt(6)
  v_mfma_f32_16x16x32_bf16 v[228:231], a[12:15], a[216:219], v[228:231]
  ds_read_b128 a[212:215], v8 offset:31744
  s_waitcnt lgkmcnt(6)
  v_mfma_f32_16x16x32_bf16 v[224:227], a[12:15], a[188:191], v[224:227]
  ds_read_b128 a[216:219], v8 offset:45056
  s_waitcnt lgkmcnt(6)
  v_mfma_f32_16x16x32_bf16 v[232:235], a[12:15], a[192:195], v[232:235]
  buffer_load_dwordx4 a[120:123], v0, s[28:31], s66 offen offset:896 sc1
  ds_read_b128 a[188:191], v9 offset:31744
  s_waitcnt lgkmcnt(6)
  v_mfma_f32_16x16x32_bf16 v[220:223], a[16:19], a[196:199], v[220:223]
  ds_read_b128 a[192:195], v9 offset:45056
  s_waitcnt lgkmcnt(6)
  v_mfma_f32_16x16x32_bf16 v[228:231], a[16:19], a[200:203], v[228:231]
  ds_read_b128 a[196:199], v8 offset:32768
  s_waitcnt lgkmcnt(6)
  v_mfma_f32_16x16x32_bf16 v[224:227], a[16:19], a[204:207], v[224:227]
  ds_read_b128 a[200:203], v8 offset:46080
  s_waitcnt lgkmcnt(6)
  v_mfma_f32_16x16x32_bf16 v[232:235], a[16:19], a[208:211], v[232:235]
  s_waitcnt lgkmcnt(5)
  v_mfma_f32_16x16x32_bf16 v[220:223], a[20:23], a[212:215], v[220:223]
  ds_read_b128 a[220:223], v0 offset:0
  s_waitcnt lgkmcnt(5)
  v_mfma_f32_16x16x32_bf16 v[228:231], a[20:23], a[216:219], v[228:231]
  buffer_load_dwordx4 a[124:127], v0, s[28:31], s66 offen offset:1920 sc1
  ds_read_b128 a[224:227], v0 offset:1024
  s_waitcnt lgkmcnt(5)
  v_mfma_f32_16x16x32_bf16 v[224:227], a[20:23], a[188:191], v[224:227]
  ds_read_b128 a[228:231], v0 offset:2048
  s_waitcnt lgkmcnt(5)
  v_mfma_f32_16x16x32_bf16 v[232:235], a[20:23], a[192:195], v[232:235]
  ds_read_b128 a[232:235], v0 offset:3072
  s_waitcnt lgkmcnt(5)
  v_mfma_f32_16x16x32_bf16 v[220:223], a[24:27], a[196:199], v[220:223]
  ds_read_b128 a[236:239], v0 offset:4096
  s_waitcnt lgkmcnt(5)
  v_mfma_f32_16x16x32_bf16 v[228:231], a[24:27], a[200:203], v[228:231]
  buffer_load_dwordx4 a[128:131], v0, s[28:31], s66 offen offset:2944 sc1
  buffer_load_dwordx4 a[132:135], v0, s[28:31], s66 offen offset:3968 sc1
  buffer_load_dwordx4 a[136:139], v1, s[28:31], s67 offen offset:896 sc1
  ds_read_b128 a[240:243], v0 offset:5120
  s_add_u32 s49, s49, 1
  s_cmp_lt_u32 s49, 5
  s_cbranch_scc1 standalone__cross_network_dcn_v2__recsys_kernel_loopR
  s_waitcnt vmcnt(24) lgkmcnt(5)
  v_mfma_f32_32x32x16_bf16 v[12:27], a[28:31], a[220:223], v[12:27]
  ds_read_b128 a[244:247], v0 offset:6144
  v_add_f32 v220, v220, v226
  v_add_f32 v221, v221, v227
  v_cvt_pk_bf16_f32 v224, v220, v221
  ds_write_b32 v2, v224 offset:7168
  v_add_f32 v228, v228, v234
  v_add_f32 v229, v229, v235
  v_cvt_pk_bf16_f32 v232, v228, v229
  ds_write_b32 v2, v232 offset:7424
  s_waitcnt lgkmcnt(7)
  v_mfma_f32_32x32x16_bf16 v[12:27], a[32:35], a[224:227], v[12:27]
  s_waitcnt lgkmcnt(6)
  v_mfma_f32_32x32x16_bf16 v[12:27], a[36:39], a[228:231], v[12:27]
  s_waitcnt lgkmcnt(5)
  v_mfma_f32_32x32x16_bf16 v[12:27], a[40:43], a[232:235], v[12:27]
  s_waitcnt vmcnt(20) lgkmcnt(4)
  v_mfma_f32_32x32x16_bf16 v[12:27], a[44:47], a[236:239], v[12:27]
  s_waitcnt lgkmcnt(3)
  v_mfma_f32_32x32x16_bf16 v[12:27], a[48:51], a[240:243], v[12:27]
  s_waitcnt lgkmcnt(2)
  v_mfma_f32_32x32x16_bf16 v[12:27], a[52:55], a[244:247], v[12:27]
  v_mfma_f32_32x32x16_bf16 v[28:43], a[56:59], a[220:223], v[28:43]
  s_waitcnt vmcnt(16)
  v_mfma_f32_32x32x16_bf16 v[28:43], a[60:63], a[224:227], v[28:43]
  s_nop 8
  v_mul_f32 v244, v140, v12
  v_mul_f32 v245, v141, v13
  v_cvt_pk_bf16_f32 v236, v244, v245
  v_mul_f32 v246, v142, v14
  v_mul_f32 v247, v143, v15
  v_mfma_f32_32x32x16_bf16 v[28:43], a[64:67], a[228:231], v[28:43]
  v_cvt_pk_bf16_f32 v237, v246, v247
  v_mul_f32 v244, v144, v16
  v_mul_f32 v245, v145, v17
  v_cvt_pk_bf16_f32 v238, v244, v245
  v_mul_f32 v246, v146, v18
  v_mfma_f32_32x32x16_bf16 v[28:43], a[68:71], a[232:235], v[28:43]
  v_mul_f32 v247, v147, v19
  v_cvt_pk_bf16_f32 v239, v246, v247
  v_mul_f32 v244, v148, v20
  v_mul_f32 v245, v149, v21
  v_cvt_pk_bf16_f32 v240, v244, v245
  v_mfma_f32_32x32x16_bf16 v[28:43], a[72:75], a[236:239], v[28:43]
  ds_write_b128 v6, v[236:239] offset:4096
  v_mul_f32 v246, v150, v22
  s_waitcnt vmcnt(12)
  v_mfma_f32_32x32x16_bf16 v[28:43], a[76:79], a[240:243], v[28:43]
  v_mul_f32 v247, v151, v23
  v_cvt_pk_bf16_f32 v241, v246, v247
  v_mul_f32 v244, v152, v24
  v_mul_f32 v245, v153, v25
  v_cvt_pk_bf16_f32 v242, v244, v245
  v_mfma_f32_32x32x16_bf16 v[28:43], a[80:83], a[244:247], v[28:43]
  v_mul_f32 v246, v154, v26
  v_mul_f32 v247, v155, v27
  v_cvt_pk_bf16_f32 v243, v246, v247
  v_mfma_f32_32x32x16_bf16 v[44:59], a[84:87], a[220:223], v[44:59]
  ds_write_b128 v7, v[240:243] offset:4096
  v_mfma_f32_32x32x16_bf16 v[44:59], a[88:91], a[224:227], v[44:59]
  v_accvgpr_read_b32 v244, a140
  v_accvgpr_read_b32 v245, a141
  s_nop 3
  v_mul_f32 v244, v244, v28
  v_mul_f32 v245, v245, v29
  v_cvt_pk_bf16_f32 v236, v244, v245
  s_waitcnt vmcnt(8)
  v_mfma_f32_32x32x16_bf16 v[44:59], a[92:95], a[228:231], v[44:59]
  v_accvgpr_read_b32 v246, a142
  v_accvgpr_read_b32 v247, a143
  v_mul_f32 v246, v246, v30
  v_mul_f32 v247, v247, v31
  v_cvt_pk_bf16_f32 v237, v246, v247
  v_mfma_f32_32x32x16_bf16 v[44:59], a[96:99], a[232:235], v[44:59]
  v_accvgpr_read_b32 v244, a144
  v_accvgpr_read_b32 v245, a145
  v_mul_f32 v244, v244, v32
  v_mul_f32 v245, v245, v33
  v_cvt_pk_bf16_f32 v238, v244, v245
  v_mfma_f32_32x32x16_bf16 v[44:59], a[100:103], a[236:239], v[44:59]
  v_accvgpr_read_b32 v246, a146
  v_accvgpr_read_b32 v247, a147
  v_mul_f32 v246, v246, v34
  v_mul_f32 v247, v247, v35
  v_cvt_pk_bf16_f32 v239, v246, v247
  v_mfma_f32_32x32x16_bf16 v[44:59], a[104:107], a[240:243], v[44:59]
  ds_write_b128 v4, v[236:239] offset:5120
  v_accvgpr_read_b32 v244, a148
  s_waitcnt vmcnt(4)
  v_mfma_f32_32x32x16_bf16 v[44:59], a[108:111], a[244:247], v[44:59]
  v_accvgpr_read_b32 v245, a149
  v_mul_f32 v244, v244, v36
  v_mul_f32 v245, v245, v37
  v_cvt_pk_bf16_f32 v240, v244, v245
  v_accvgpr_read_b32 v246, a150
  s_waitcnt lgkmcnt(3)
  s_barrier
  v_mfma_f32_32x32x16_bf16 v[60:75], a[112:115], a[220:223], v[60:75]
  ds_read_b128 a[220:223], v0 offset:7168
  v_accvgpr_read_b32 v247, a151
  v_mul_f32 v246, v246, v38
  v_mul_f32 v247, v247, v39
  v_cvt_pk_bf16_f32 v241, v246, v247
  v_mfma_f32_32x32x16_bf16 v[60:75], a[116:119], a[224:227], v[60:75]
  ds_read_b128 a[224:227], v0 offset:8192
  v_accvgpr_read_b32 v244, a152
  v_accvgpr_read_b32 v245, a153
  v_mul_f32 v244, v244, v40
  v_mul_f32 v245, v245, v41
  v_mfma_f32_32x32x16_bf16 v[60:75], a[120:123], a[228:231], v[60:75]
  ds_read_b128 a[228:231], v0 offset:9216
  v_cvt_pk_bf16_f32 v242, v244, v245
  v_accvgpr_read_b32 v246, a154
  v_accvgpr_read_b32 v247, a155
  v_mul_f32 v246, v246, v42
  s_waitcnt vmcnt(0)
  v_mfma_f32_32x32x16_bf16 v[60:75], a[124:127], a[232:235], v[60:75]
  ds_read_b128 a[232:235], v0 offset:10240
  v_mul_f32 v247, v247, v43
  v_cvt_pk_bf16_f32 v243, v246, v247
  v_accvgpr_read_b32 v244, a156
  v_accvgpr_read_b32 v245, a157
  v_mfma_f32_32x32x16_bf16 v[60:75], a[128:131], a[236:239], v[60:75]
  ds_read_b128 a[236:239], v0 offset:11264
  ds_write_b128 v5, v[240:243] offset:5120
  v_mfma_f32_32x32x16_bf16 v[60:75], a[132:135], a[240:243], v[60:75]
  ds_read_b128 a[240:243], v0 offset:12288
  v_mul_f32 v244, v244, v44
  v_mul_f32 v245, v245, v45
  v_cvt_pk_bf16_f32 v236, v244, v245
  v_accvgpr_read_b32 v246, a158
  v_mfma_f32_32x32x16_bf16 v[60:75], a[136:139], a[244:247], v[60:75]
  ds_read_b128 a[244:247], v0 offset:13312
  v_accvgpr_read_b32 v247, a159
  v_mul_f32 v246, v246, v46
  v_mul_f32 v247, v247, v47
  v_cvt_pk_bf16_f32 v237, v246, v247
  s_waitcnt lgkmcnt(7)
  v_mfma_f32_32x32x16_bf16 v[76:91], a[28:31], a[220:223], v[76:91]
  v_accvgpr_read_b32 v244, a160
  v_accvgpr_read_b32 v245, a161
  v_mul_f32 v244, v244, v48
  v_mul_f32 v245, v245, v49
  v_cvt_pk_bf16_f32 v238, v244, v245
  s_waitcnt lgkmcnt(6)
  v_mfma_f32_32x32x16_bf16 v[76:91], a[32:35], a[224:227], v[76:91]
  v_accvgpr_read_b32 v246, a162
  v_accvgpr_read_b32 v247, a163
  v_mul_f32 v246, v246, v50
  v_mul_f32 v247, v247, v51
  v_cvt_pk_bf16_f32 v239, v246, v247
  s_waitcnt lgkmcnt(5)
  v_mfma_f32_32x32x16_bf16 v[76:91], a[36:39], a[228:231], v[76:91]
  ds_write_b128 v6, v[236:239] offset:5120
  v_accvgpr_read_b32 v244, a164
  s_waitcnt lgkmcnt(5)
  v_mfma_f32_32x32x16_bf16 v[76:91], a[40:43], a[232:235], v[76:91]
  v_accvgpr_read_b32 v245, a165
  v_mul_f32 v244, v244, v52
  v_mul_f32 v245, v245, v53
  v_cvt_pk_bf16_f32 v240, v244, v245
  v_accvgpr_read_b32 v246, a166
  s_waitcnt lgkmcnt(4)
  v_mfma_f32_32x32x16_bf16 v[76:91], a[44:47], a[236:239], v[76:91]
  v_accvgpr_read_b32 v247, a167
  v_mul_f32 v246, v246, v54
  v_mul_f32 v247, v247, v55
  v_cvt_pk_bf16_f32 v241, v246, v247
  v_accvgpr_read_b32 v244, a168
  s_waitcnt lgkmcnt(2)
  v_mfma_f32_32x32x16_bf16 v[76:91], a[48:51], a[240:243], v[76:91]
  v_accvgpr_read_b32 v245, a169
  v_mul_f32 v244, v244, v56
  v_mul_f32 v245, v245, v57
  v_cvt_pk_bf16_f32 v242, v244, v245
  v_accvgpr_read_b32 v246, a170
  s_waitcnt lgkmcnt(1)
  v_mfma_f32_32x32x16_bf16 v[76:91], a[52:55], a[244:247], v[76:91]
  v_accvgpr_read_b32 v247, a171
  v_mul_f32 v246, v246, v58
  v_mul_f32 v247, v247, v59
  v_cvt_pk_bf16_f32 v243, v246, v247
  v_mul_f32 v244, v156, v60
  v_mfma_f32_32x32x16_bf16 v[92:107], a[56:59], a[220:223], v[92:107]
  ds_write_b128 v7, v[240:243] offset:5120
  v_mul_f32 v245, v157, v61
  v_mfma_f32_32x32x16_bf16 v[92:107], a[60:63], a[224:227], v[92:107]
  v_cvt_pk_bf16_f32 v236, v244, v245
  v_mul_f32 v246, v158, v62
  v_mul_f32 v247, v159, v63
  v_cvt_pk_bf16_f32 v237, v246, v247
  v_mul_f32 v244, v160, v64
  v_mfma_f32_32x32x16_bf16 v[92:107], a[64:67], a[228:231], v[92:107]
  v_mul_f32 v245, v161, v65
  v_cvt_pk_bf16_f32 v238, v244, v245
  v_mul_f32 v246, v162, v66
  v_mul_f32 v247, v163, v67
  v_cvt_pk_bf16_f32 v239, v246, v247
  v_mfma_f32_32x32x16_bf16 v[92:107], a[68:71], a[232:235], v[92:107]
  ds_write_b128 v4, v[236:239] offset:6144
  v_mul_f32 v244, v164, v68
  v_mfma_f32_32x32x16_bf16 v[92:107], a[72:75], a[236:239], v[92:107]
  v_mul_f32 v245, v165, v69
  v_cvt_pk_bf16_f32 v240, v244, v245
  v_mul_f32 v246, v166, v70
  v_mul_f32 v247, v167, v71
  v_cvt_pk_bf16_f32 v241, v246, v247
  v_mfma_f32_32x32x16_bf16 v[92:107], a[76:79], a[240:243], v[92:107]
  v_mul_f32 v244, v168, v72
  v_mul_f32 v245, v169, v73
  v_cvt_pk_bf16_f32 v242, v244, v245
  v_mul_f32 v246, v170, v74
  v_mul_f32 v247, v171, v75
  v_mfma_f32_32x32x16_bf16 v[92:107], a[80:83], a[244:247], v[92:107]
  v_cvt_pk_bf16_f32 v243, v246, v247
  ds_write_b128 v5, v[240:243] offset:6144
  s_waitcnt lgkmcnt(0)
  s_barrier
  v_mfma_f32_32x32x16_bf16 v[108:123], a[84:87], a[220:223], v[108:123]
  v_mul_f32 v244, v172, v76
  v_mul_f32 v245, v173, v77
  v_cvt_pk_bf16_f32 v236, v244, v245
  v_mul_f32 v246, v174, v78
  v_mul_f32 v247, v175, v79
  ds_read_b128 a[188:191], v10 offset:0
  ds_read_b128 a[192:195], v10 offset:1024
  v_mfma_f32_32x32x16_bf16 v[108:123], a[88:91], a[224:227], v[108:123]
  v_cvt_pk_bf16_f32 v237, v246, v247
  v_mul_f32 v244, v176, v80
  v_mul_f32 v245, v177, v81
  v_cvt_pk_bf16_f32 v238, v244, v245
  v_mul_f32 v246, v178, v82
  ds_read_b128 a[196:199], v10 offset:2048
  ds_read_b128 a[200:203], v10 offset:3072
  v_mfma_f32_32x32x16_bf16 v[108:123], a[92:95], a[228:231], v[108:123]
  v_mul_f32 v247, v179, v83
  v_cvt_pk_bf16_f32 v239, v246, v247
  v_mul_f32 v244, v180, v84
  v_mul_f32 v245, v181, v85
  v_cvt_pk_bf16_f32 v240, v244, v245
  ds_read_b128 a[204:207], v10 offset:13312
  ds_read_b128 a[208:211], v10 offset:14336
  v_mfma_f32_32x32x16_bf16 v[108:123], a[96:99], a[232:235], v[108:123]
  ds_write_b128 v6, v[236:239] offset:30720
  v_mul_f32 v246, v182, v86
  ds_read_b128 a[212:215], v10 offset:15360
  ds_read_b128 a[216:219], v10 offset:16384
  s_waitcnt lgkmcnt(7)
  buffer_store_dwordx4 a[188:191], v3, s[24:27], s56 offen nt
  v_mfma_f32_32x32x16_bf16 v[108:123], a[100:103], a[236:239], v[108:123]
  v_mul_f32 v247, v183, v87
  v_cvt_pk_bf16_f32 v241, v246, v247
  v_mul_f32 v244, v184, v88
  v_mul_f32 v245, v185, v89
  v_cvt_pk_bf16_f32 v242, v244, v245
  buffer_store_dwordx4 a[192:195], v3, s[24:27], s56 offen offset:128 nt
  v_mfma_f32_32x32x16_bf16 v[108:123], a[104:107], a[240:243], v[108:123]
  v_mul_f32 v246, v186, v90
  v_mul_f32 v247, v187, v91
  v_cvt_pk_bf16_f32 v243, v246, v247
  v_accvgpr_read_b32 v244, a172
  v_accvgpr_read_b32 v245, a173
  s_waitcnt lgkmcnt(5)
  buffer_store_dwordx4 a[196:199], v3, s[24:27], s56 offen offset:256 nt
  v_mfma_f32_32x32x16_bf16 v[108:123], a[108:111], a[244:247], v[108:123]
  ds_write_b128 v7, v[240:243] offset:30720
  v_mul_f32 v244, v244, v92
  buffer_store_dwordx4 a[200:203], v3, s[24:27], s56 offen offset:384 nt
  v_mfma_f32_32x32x16_bf16 v[124:139], a[112:115], a[220:223], v[124:139]
  v_mul_f32 v245, v245, v93
  v_cvt_pk_bf16_f32 v236, v244, v245
  v_accvgpr_read_b32 v246, a174
  v_accvgpr_read_b32 v247, a175
  v_mul_f32 v246, v246, v94
  s_waitcnt lgkmcnt(4)
  buffer_store_dwordx4 a[204:207], v3, s[24:27], s57 offen nt
  v_mfma_f32_32x32x16_bf16 v[124:139], a[116:119], a[224:227], v[124:139]
  v_mul_f32 v247, v247, v95
  v_cvt_pk_bf16_f32 v237, v246, v247
  v_accvgpr_read_b32 v244, a176
  v_accvgpr_read_b32 v245, a177
  v_mul_f32 v244, v244, v96
  buffer_store_dwordx4 a[208:211], v3, s[24:27], s57 offen offset:128 nt
  v_mfma_f32_32x32x16_bf16 v[124:139], a[120:123], a[228:231], v[124:139]
  v_mul_f32 v245, v245, v97
  v_cvt_pk_bf16_f32 v238, v244, v245
  v_accvgpr_read_b32 v246, a178
  v_accvgpr_read_b32 v247, a179
  v_mul_f32 v246, v246, v98
  s_waitcnt lgkmcnt(1)
  buffer_store_dwordx4 a[212:215], v3, s[24:27], s57 offen offset:256 nt
  v_mfma_f32_32x32x16_bf16 v[124:139], a[124:127], a[232:235], v[124:139]
  v_mul_f32 v247, v247, v99
  v_cvt_pk_bf16_f32 v239, v246, v247
  v_accvgpr_read_b32 v244, a180
  v_accvgpr_read_b32 v245, a181
  v_mul_f32 v244, v244, v100
  buffer_store_dwordx4 a[216:219], v3, s[24:27], s57 offen offset:384 nt
  v_mfma_f32_32x32x16_bf16 v[124:139], a[128:131], a[236:239], v[124:139]
  ds_write_b128 v4, v[236:239] offset:31744
  v_mul_f32 v245, v245, v101
  v_mfma_f32_32x32x16_bf16 v[124:139], a[132:135], a[240:243], v[124:139]
  v_cvt_pk_bf16_f32 v240, v244, v245
  v_accvgpr_read_b32 v246, a182
  v_accvgpr_read_b32 v247, a183
  v_mul_f32 v246, v246, v102
  v_mul_f32 v247, v247, v103
  v_mfma_f32_32x32x16_bf16 v[124:139], a[136:139], a[244:247], v[124:139]
  v_cvt_pk_bf16_f32 v241, v246, v247
  v_accvgpr_read_b32 v244, a184
  v_accvgpr_read_b32 v245, a185
  v_mul_f32 v244, v244, v104
  v_mul_f32 v245, v245, v105
  v_cvt_pk_bf16_f32 v242, v244, v245
  v_accvgpr_read_b32 v246, a186
  v_accvgpr_read_b32 v247, a187
  v_mul_f32 v246, v246, v106
  v_mul_f32 v247, v247, v107
  v_cvt_pk_bf16_f32 v243, v246, v247
  ds_write_b128 v5, v[240:243] offset:31744
  v_mul_f32 v244, v188, v108
  v_mul_f32 v245, v189, v109
  v_cvt_pk_bf16_f32 v236, v244, v245
  v_mul_f32 v246, v190, v110
  v_mul_f32 v247, v191, v111
  v_cvt_pk_bf16_f32 v237, v246, v247
  v_mul_f32 v244, v192, v112
  v_mul_f32 v245, v193, v113
  v_cvt_pk_bf16_f32 v238, v244, v245
  v_mul_f32 v246, v194, v114
  v_mul_f32 v247, v195, v115
  v_cvt_pk_bf16_f32 v239, v246, v247
  v_mul_f32 v244, v196, v116
  v_mul_f32 v245, v197, v117
  v_cvt_pk_bf16_f32 v240, v244, v245
  ds_write_b128 v6, v[236:239] offset:31744
  v_mul_f32 v246, v198, v118
  v_mul_f32 v247, v199, v119
  v_cvt_pk_bf16_f32 v241, v246, v247
  v_mul_f32 v244, v200, v120
  v_mul_f32 v245, v201, v121
  v_cvt_pk_bf16_f32 v242, v244, v245
  v_mul_f32 v246, v202, v122
  v_mul_f32 v247, v203, v123
  v_cvt_pk_bf16_f32 v243, v246, v247
  v_mul_f32 v244, v204, v124
  v_mul_f32 v245, v205, v125
  ds_write_b128 v7, v[240:243] offset:31744
  v_cvt_pk_bf16_f32 v236, v244, v245
  v_mul_f32 v246, v206, v126
  v_mul_f32 v247, v207, v127
  v_cvt_pk_bf16_f32 v237, v246, v247
  v_mul_f32 v244, v208, v128
  v_mul_f32 v245, v209, v129
  v_cvt_pk_bf16_f32 v238, v244, v245
  v_mul_f32 v246, v210, v130
  v_mul_f32 v247, v211, v131
  v_cvt_pk_bf16_f32 v239, v246, v247
  v_mul_f32 v244, v212, v132
  ds_write_b128 v4, v[236:239] offset:32768
  v_mul_f32 v245, v213, v133
  v_cvt_pk_bf16_f32 v240, v244, v245
  v_mul_f32 v246, v214, v134
  v_mul_f32 v247, v215, v135
  v_cvt_pk_bf16_f32 v241, v246, v247
  v_mul_f32 v244, v216, v136
  v_mul_f32 v245, v217, v137
  v_cvt_pk_bf16_f32 v242, v244, v245
  v_mul_f32 v246, v218, v138
  v_mul_f32 v247, v219, v139
  v_cvt_pk_bf16_f32 v243, v246, v247
  ds_write_b128 v5, v[240:243] offset:32768
  s_waitcnt lgkmcnt(0)
  s_barrier
  ds_read_b128 a[28:31], v10 offset:26624
  ds_read_b128 a[32:35], v10 offset:27648
  ds_read_b128 a[36:39], v10 offset:28672
  ds_read_b128 a[40:43], v10 offset:29696
  ds_read_b128 a[44:47], v10 offset:39936
  ds_read_b128 a[48:51], v10 offset:40960
  ds_read_b128 a[52:55], v10 offset:41984
  ds_read_b128 a[56:59], v10 offset:43008
  s_waitcnt lgkmcnt(0)
  buffer_store_dwordx4 a[28:31], v3, s[24:27], s58 offen nt
  buffer_store_dwordx4 a[32:35], v3, s[24:27], s58 offen offset:128 nt
  buffer_store_dwordx4 a[36:39], v3, s[24:27], s58 offen offset:256 nt
  buffer_store_dwordx4 a[40:43], v3, s[24:27], s58 offen offset:384 nt
  buffer_store_dwordx4 a[44:47], v3, s[24:27], s59 offen nt
  buffer_store_dwordx4 a[48:51], v3, s[24:27], s59 offen offset:128 nt
  buffer_store_dwordx4 a[52:55], v3, s[24:27], s59 offen offset:256 nt
  buffer_store_dwordx4 a[56:59], v3, s[24:27], s59 offen offset:384 nt
  s_endpgm
standalone__cross_network_dcn_v2__recsys_kernel_M:
  v_lshlrev_b32 v0, 4, v252
  v_lshrrev_b32 v8, 4, v252
  v_and_b32 v9, 3, v252
  v_xor_b32 v9, v9, v8
  v_lshlrev_b32 v3, 4, v9
  v_lshrrev_b32 v9, 3, v252
  v_and_b32 v9, 1, v9
  v_lshlrev_b32 v9, 2, v9
  v_or_b32 v8, v8, v9
  v_mul_u32_u24 v8, 1664, v8
  v_and_b32 v9, 4, v252
  v_lshlrev_b32 v9, 4, v9
  v_add3_u32 v3, v3, v8, v9
  s_waitcnt lgkmcnt(0)
  s_mov_b32 s20, s4
  s_mov_b32 s21, s5
  s_mov_b32 s22, 13631488
  s_mov_b32 s23, 0x20000
  s_mov_b32 s32, s8
  s_mov_b32 s33, s9
  s_mov_b32 s34, 519168
  s_mov_b32 s35, 0x20000
  s_mov_b32 s24, s12
  s_mov_b32 s25, s13
  s_mov_b32 s26, 13631488
  s_mov_b32 s27, 0x20000
  s_mov_b32 s28, s16
  s_mov_b32 s29, s17
  s_mov_b32 s30, 1051392
  s_mov_b32 s31, 0x20000
  s_mov_b32 s36, s6
  s_mov_b32 s37, s7
  s_mov_b32 s38, 519168
  s_mov_b32 s39, 0x20000
  s_mov_b32 s40, s10
  s_mov_b32 s41, s11
  s_mov_b32 s42, 4992
  s_mov_b32 s43, 0x20000
  s_mov_b32 s44, s14
  s_mov_b32 s45, s15
  s_mov_b32 s46, 256
  s_mov_b32 s47, 0x20000
  s_lshr_b32 s50, s2, 3
  s_cmp_lt_u32 s50, 22
  s_cselect_b32 s50, s50, 262144
  s_lshl_b32 s50, s50, 12
  v_lshlrev_b32 v253, 6, v252
  s_cmp_eq_u32 s48, 0
  s_cbranch_scc0 standalone__cross_network_dcn_v2__recsys_kernel_nvp
  buffer_load_dword v255, v253, s[32:35], s50 offen
standalone__cross_network_dcn_v2__recsys_kernel_nvp:
  s_cmp_eq_u32 s48, 2
  s_cbranch_scc0 standalone__cross_network_dcn_v2__recsys_kernel_nup
  buffer_load_dword v255, v253, s[36:39], s50 offen
standalone__cross_network_dcn_v2__recsys_kernel_nup:
  v_and_b32 v250, 31, v252
  v_and_b32 v251, 0x13, v250
  v_and_b32 v253, 4, v250
  v_lshlrev_b32 v253, 1, v253
  v_or_b32 v251, v251, v253
  v_and_b32 v253, 8, v250
  v_lshrrev_b32 v253, 1, v253
  v_or_b32 v251, v251, v253
  v_lshlrev_b32 v250, 1, v251
  s_mul_i32 s50, s48, 192
  buffer_load_ushort v204, v250, s[40:43], s50 offen
  buffer_load_ushort v205, v250, s[40:43], s50 offen offset:64
  buffer_load_ushort v206, v250, s[40:43], s50 offen offset:128
  s_barrier
  s_mul_i32 s50, s48, 26624
  s_add_u32 s51, s50, 13312
  v_xor_b32 v250, 32, v3
  s_add_u32 s52, s48, 0
  s_min_u32 s52, s52, 12
  s_lshl_b32 s53, s52, 10
  s_add_u32 m0, s53, 147456
  s_lshl_b32 s53, s52, 7
  s_add_u32 s53, s53, 79872
  s_mov_b32 exec_lo, 0x00ff00ff
  s_mov_b32 exec_hi, 0x00ff00ff
  buffer_load_dwordx4 v3, s[32:35], s53 offen lds
  s_mov_b64 exec, -1
  v_and_b32 v240, 31, v252
  v_lshrrev_b32 v241, 5, v252
  v_lshrrev_b32 v242, 1, v240
  v_and_b32 v242, 7, v242
  v_and_b32 v243, 1, v240
  v_lshrrev_b32 v244, 4, v240
  v_mul_u32_u24 v244, 13312, v244
  v_and_b32 v246, 3, v242
  v_lshlrev_b32 v247, 8, v246
  v_add_u32 v244, v244, v247
  v_lshrrev_b32 v247, 2, v242
  v_lshlrev_b32 v247, 7, v247
  v_add_u32 v244, v244, v247
  v_mul_u32_u24 v247, 6144, v243
  v_add_u32 v244, v244, v247
  v_add_u32 v244, 14336, v244
  v_xor_b32 v245, v241, v246
  v_lshlrev_b32 v245, 4, v245
  v_lshlrev_b32 v246, 6, v243
  v_add3_u32 v4, v244, v246, v245
  v_xor_b32 v247, 32, v245
  v_add3_u32 v5, v244, v246, v247
  v_xor_b32 v246, 64, v246
  v_lshlrev_b32 v243, 10, v243
  v_add3_u32 v244, v244, v246, v243
  v_add_u32 v6, v244, v245
  v_add_u32 v7, v244, v247
  s_mul_i32 s71, s48, 3
  s_lshr_b32 s72, s71, 1
  s_lshl_b32 s72, s72, 10
  s_add_u32 s73, s71, 1
  s_lshr_b32 s73, s73, 1
  s_lshl_b32 s73, s73, 10
  s_add_u32 s52, s48, 3
  s_min_u32 s52, s52, 12
  s_lshl_b32 s53, s52, 10
  s_add_u32 m0, s53, 147456
  s_lshl_b32 s53, s52, 7
  s_add_u32 s53, s53, 79872
  s_mov_b32 exec_lo, 0x00ff00ff
  s_mov_b32 exec_hi, 0x00ff00ff
  buffer_load_dwordx4 v3, s[32:35], s53 offen lds
  s_mov_b64 exec, -1
  s_and_b32 s74, s48, 1
  s_cmp_eq_u32 s74, 0
  s_cbranch_scc0 standalone__cross_network_dcn_v2__recsys_kernel_odd
  v_add_u32 v8, s72, v4
  v_add_u32 v9, s72, v5
  v_add_u32 v10, s73, v6
  v_add_u32 v11, s73, v7
  s_branch standalone__cross_network_dcn_v2__recsys_kernel_oddd
standalone__cross_network_dcn_v2__recsys_kernel_odd:
  v_add_u32 v8, s72, v6
  v_add_u32 v9, s72, v7
  v_add_u32 v10, s73, v4
  v_add_u32 v11, s73, v5
standalone__cross_network_dcn_v2__recsys_kernel_oddd:
  s_lshl_b32 s72, s48, 11
  v_and_b32 v240, 15, v252
  v_lshrrev_b32 v241, 4, v252
  v_lshrrev_b32 v242, 1, v241
  v_lshlrev_b32 v242, 10, v242
  v_and_b32 v243, 1, v241
  v_lshlrev_b32 v243, 9, v243
  v_lshlrev_b32 v244, 4, v240
  v_add3_u32 v242, v242, v243, v244
  v_add_u32 v2, s72, v242
  s_mul_i32 s72, s48, 3072
  s_add_u32 s72, s72, 14336
  v_add_u32 v248, s72, v0
  v_lshlrev_b32 v246, 2, v252
  v_subrev_u32 v246, 128, v246
  v_add_u32 v247, 128, v0
  v_cmp_gt_u32 vcc, 32, v252
  s_nop 1
  v_cndmask_b32 v1, v246, v247, vcc
  v_lshrrev_b32 v242, 1, v240
  v_and_b32 v243, 1, v240
  v_and_b32 v245, 3, v242
  v_lshlrev_b32 v244, 8, v245
  v_lshrrev_b32 v246, 2, v242
  v_lshlrev_b32 v246, 7, v246
  v_add_u32 v244, v244, v246
  v_xor_b32 v245, v241, v245
  v_lshlrev_b32 v245, 4, v245
  v_add_u32 v244, v244, v245
  v_add_u32 v244, 14336, v244
  v_mul_u32_u24 v246, 6144, v243
  v_add_u32 v244, v244, v246
  v_xor_b32 v243, 0, v243
  s_add_u32 s52, s48, 6
  s_min_u32 s52, s52, 12
  s_lshl_b32 s53, s52, 10
  s_add_u32 m0, s53, 147456
  s_lshl_b32 s53, s52, 7
  s_add_u32 s53, s53, 79872
  s_mov_b32 exec_lo, 0x00ff00ff
  s_mov_b32 exec_hi, 0x00ff00ff
  buffer_load_dwordx4 v3, s[32:35], s53 offen lds
  s_mov_b64 exec, -1
  v_lshlrev_b32 v243, 6, v243
  v_add_u32 v4, v244, v243
  v_lshrrev_b32 v242, 1, v240
  v_and_b32 v243, 1, v240
  v_and_b32 v245, 3, v242
  v_lshlrev_b32 v244, 8, v245
  v_lshrrev_b32 v246, 2, v242
  v_lshlrev_b32 v246, 7, v246
  v_add_u32 v244, v244, v246
  v_xor_b32 v245, v241, v245
  v_lshlrev_b32 v245, 4, v245
  v_add_u32 v244, v244, v245
  v_add_u32 v244, 14336, v244
  v_mul_u32_u24 v246, 7168, v243
  v_add_u32 v244, v244, v246
  v_xor_b32 v243, 1, v243
  v_lshlrev_b32 v243, 6, v243
  v_add_u32 v5, v244, v243
  s_mul_i32 s72, s48, 26624
  s_add_u32 s72, s72, 67584
  v_lshrrev_b32 v236, 3, v240
  v_mul_u32_u24 v237, 13312, v236
  v_lshlrev_b32 v236, 5, v236
  v_and_b32 v238, 4, v240
  v_lshlrev_b32 v238, 1, v238
  v_and_b32 v239, 3, v240
  v_add_u32 v238, v238, v239
  v_add_u32 v239, 4, v238
  v_lshrrev_b32 v242, 1, v238
  v_and_b32 v243, 1, v238
  v_and_b32 v245, 3, v242
  v_lshlrev_b32 v244, 8, v245
  v_lshrrev_b32 v246, 2, v242
  s_add_u32 s52, s48, 9
  s_min_u32 s52, s52, 12
  s_lshl_b32 s53, s52, 10
  s_add_u32 m0, s53, 147456
  s_lshl_b32 s53, s52, 7
  s_add_u32 s53, s53, 79872
  s_mov_b32 exec_lo, 0x00ff00ff
  s_mov_b32 exec_hi, 0x00ff00ff
  buffer_load_dwordx4 v3, s[32:35], s53 offen lds
  s_mov_b64 exec, -1
  v_lshlrev_b32 v246, 7, v246
  v_add_u32 v244, v244, v246
  v_xor_b32 v245, v241, v245
  v_lshlrev_b32 v245, 4, v245
  v_add_u32 v244, v244, v245
  v_add_u32 v244, s72, v244
  v_mul_u32_u24 v246, 6144, v243
  v_add_u32 v244, v244, v246
  v_xor_b32 v243, 0, v243
  v_lshlrev_b32 v243, 6, v243
  v_add_u32 v232, v244, v243
  v_lshrrev_b32 v242, 1, v238
  v_and_b32 v243, 1, v238
  v_and_b32 v245, 3, v242
  v_lshlrev_b32 v244, 8, v245
  v_lshrrev_b32 v246, 2, v242
  v_lshlrev_b32 v246, 7, v246
  v_add_u32 v244, v244, v246
  v_xor_b32 v245, v241, v245
  v_lshlrev_b32 v245, 4, v245
  v_add_u32 v244, v244, v245
  v_add_u32 v244, s72, v244
  v_mul_u32_u24 v246, 7168, v243
  v_add_u32 v244, v244, v246
  v_xor_b32 v243, 1, v243
  v_lshlrev_b32 v243, 6, v243
  v_add_u32 v233, v244, v243
  v_lshrrev_b32 v242, 1, v239
  v_and_b32 v243, 1, v239
  v_and_b32 v245, 3, v242
  v_lshlrev_b32 v244, 8, v245
  v_lshrrev_b32 v246, 2, v242
  v_lshlrev_b32 v246, 7, v246
  s_add_u32 s52, s48, 12
  s_min_u32 s52, s52, 12
  s_lshl_b32 s53, s52, 10
  s_add_u32 m0, s53, 147456
  s_lshl_b32 s53, s52, 7
  s_add_u32 s53, s53, 79872
  s_mov_b32 exec_lo, 0x00ff00ff
  s_mov_b32 exec_hi, 0x00ff00ff
  s_cmp_eq_u32 s48, 0
  s_cbranch_scc0 standalone__cross_network_dcn_v2__recsys_kernel_v3s
  buffer_load_dwordx4 v3, s[32:35], s53 offen lds
standalone__cross_network_dcn_v2__recsys_kernel_v3s:
  s_mov_b64 exec, -1
  v_add_u32 v244, v244, v246
  v_xor_b32 v245, v241, v245
  v_lshlrev_b32 v245, 4, v245
  v_add_u32 v244, v244, v245
  v_add_u32 v244, s72, v244
  v_mul_u32_u24 v246, 6144, v243
  v_add_u32 v244, v244, v246
  v_xor_b32 v243, 0, v243
  v_lshlrev_b32 v243, 6, v243
  v_add_u32 v234, v244, v243
  v_lshrrev_b32 v242, 1, v239
  v_and_b32 v243, 1, v239
  v_and_b32 v245, 3, v242
  v_lshlrev_b32 v244, 8, v245
  v_lshrrev_b32 v246, 2, v242
  v_lshlrev_b32 v246, 7, v246
  v_add_u32 v244, v244, v246
  v_xor_b32 v245, v241, v245
  v_lshlrev_b32 v245, 4, v245
  v_add_u32 v244, v244, v245
  v_add_u32 v244, s72, v244
  v_mul_u32_u24 v246, 7168, v243
  v_add_u32 v244, v244, v246
  v_xor_b32 v243, 1, v243
  v_lshlrev_b32 v243, 6, v243
  v_add_u32 v235, v244, v243
  v_xor_b32 v232, v232, v236
  v_xor_b32 v233, v233, v236
  v_xor_b32 v234, v234, v236
  v_xor_b32 v235, v235, v236
  v_add_u32 v232, v232, v237
  v_add_u32 v233, v233, v237
  v_add_u32 v234, v234, v237
  s_add_u32 m0, s50, 67584
  s_nop 0
  buffer_load_dwordx4 v3, s[32:35], s50 offen offset:0 lds
  v_add_u32 v235, v235, v237
  v_mov_b32 v12, 1.0
  v_mov_b32 v13, 1.0
  v_mov_b32 v14, 1.0
  v_mov_b32 v15, 1.0
  v_mov_b32 v16, 1.0
  v_mov_b32 v17, 1.0
  v_mov_b32 v18, 1.0
  v_mov_b32 v19, 1.0
  v_mov_b32 v20, 1.0
  v_mov_b32 v21, 1.0
  v_mov_b32 v22, 1.0
  v_mov_b32 v23, 1.0
  v_mov_b32 v24, 1.0
  v_mov_b32 v25, 1.0
  v_mov_b32 v26, 1.0
  v_mov_b32 v27, 1.0
  v_mov_b32 v28, 1.0
  v_mov_b32 v29, 1.0
  v_mov_b32 v30, 1.0
  v_mov_b32 v31, 1.0
  v_mov_b32 v32, 1.0
  v_mov_b32 v33, 1.0
  v_mov_b32 v34, 1.0
  v_mov_b32 v35, 1.0
  v_mov_b32 v36, 1.0
  v_mov_b32 v37, 1.0
  v_mov_b32 v38, 1.0
  v_mov_b32 v39, 1.0
  v_mov_b32 v40, 1.0
  v_mov_b32 v41, 1.0
  v_mov_b32 v42, 1.0
  v_mov_b32 v43, 1.0
  s_add_u32 m0, s51, 67584
  s_nop 0
  buffer_load_dwordx4 v250, s[32:35], s51 offen offset:0 lds
  v_mov_b32 v44, 1.0
  v_mov_b32 v45, 1.0
  v_mov_b32 v46, 1.0
  v_mov_b32 v47, 1.0
  v_mov_b32 v48, 1.0
  v_mov_b32 v49, 1.0
  v_mov_b32 v50, 1.0
  v_mov_b32 v51, 1.0
  v_mov_b32 v52, 1.0
  v_mov_b32 v53, 1.0
  v_mov_b32 v54, 1.0
  v_mov_b32 v55, 1.0
  v_mov_b32 v56, 1.0
  v_mov_b32 v57, 1.0
  v_mov_b32 v58, 1.0
  v_mov_b32 v59, 1.0
  v_mov_b32 v60, 1.0
  v_mov_b32 v61, 1.0
  v_mov_b32 v62, 1.0
  v_mov_b32 v63, 1.0
  v_mov_b32 v64, 1.0
  v_mov_b32 v65, 1.0
  v_mov_b32 v66, 1.0
  v_mov_b32 v67, 1.0
  v_mov_b32 v68, 1.0
  v_mov_b32 v69, 1.0
  v_mov_b32 v70, 1.0
  v_mov_b32 v71, 1.0
  v_mov_b32 v72, 1.0
  v_mov_b32 v73, 1.0
  v_mov_b32 v74, 1.0
  v_mov_b32 v75, 1.0
  v_mov_b32 v76, 1.0
  s_add_u32 m0, s50, 72960
  s_nop 0
  buffer_load_dwordx4 v3, s[32:35], s50 offen offset:768 lds
  v_mov_b32 v77, 1.0
  v_mov_b32 v78, 1.0
  v_mov_b32 v79, 1.0
  v_mov_b32 v80, 1.0
  v_mov_b32 v81, 1.0
  v_mov_b32 v82, 1.0
  v_mov_b32 v83, 1.0
  v_mov_b32 v84, 1.0
  v_mov_b32 v85, 1.0
  v_mov_b32 v86, 1.0
  v_mov_b32 v87, 1.0
  v_mov_b32 v88, 1.0
  v_mov_b32 v89, 1.0
  v_mov_b32 v90, 1.0
  v_mov_b32 v91, 1.0
  v_mov_b32 v92, 1.0
  v_mov_b32 v93, 1.0
  v_mov_b32 v94, 1.0
  v_mov_b32 v95, 1.0
  v_mov_b32 v96, 1.0
  v_mov_b32 v97, 1.0
  v_mov_b32 v98, 1.0
  v_mov_b32 v99, 1.0
  v_mov_b32 v100, 1.0
  v_mov_b32 v101, 1.0
  v_mov_b32 v102, 1.0
  v_mov_b32 v103, 1.0
  v_mov_b32 v104, 1.0
  v_mov_b32 v105, 1.0
  v_mov_b32 v106, 1.0
  v_mov_b32 v107, 1.0
  s_mov_b32 s60, 4096
  s_mov_b32 s61, 8192
  s_add_u32 m0, s51, 72960
  s_nop 0
  buffer_load_dwordx4 v250, s[32:35], s51 offen offset:768 lds
  s_mov_b32 s62, 12288
  s_mov_b32 s63, 16384
  s_mov_b32 s64, 20480
  s_mov_b32 s65, 24576
  s_mov_b32 s66, 28672
  s_mov_b32 s67, 32768
  s_mov_b32 s68, 36864
  s_mov_b32 s69, 40960
  s_mov_b32 s70, 45056
  s_mul_i32 s71, s48, 46976
  s_mul_i32 s72, s48, 384
  s_add_u32 s28, s16, s71
  s_addc_u32 s29, s17, 0
  s_mov_b32 s30, 1051392
  s_add_u32 s72, s72, s55
  s_mov_b32 s56, s72
  s_add_u32 s57, s72, 13312
  s_add_u32 s58, s72, 26624
  s_add_u32 s59, s72, 39936
  s_mov_b32 s49, 0
  v_and_b32 v240, 31, v252
  v_and_b32 v241, 0x13, v240
  v_and_b32 v242, 4, v240
  v_lshlrev_b32 v242, 1, v242
  v_or_b32 v241, v241, v242
  v_and_b32 v242, 8, v240
  v_lshrrev_b32 v242, 1, v242
  v_or_b32 v241, v241, v242
  v_mul_u32_u24 v242, 208, v241
  v_lshrrev_b32 v243, 5, v252
  v_lshlrev_b32 v243, 4, v243
  s_mul_i32 s72, s48, 20480
  s_add_u32 s72, s72, 67584
  v_add3_u32 v249, v242, v243, s72
  s_add_u32 m0, s50, 73856
  s_nop 0
  buffer_load_dwordx4 v3, s[32:35], s50 offen offset:896 lds
  s_add_u32 m0, s51, 73856
  s_nop 0
  buffer_load_dwordx4 v250, s[32:35], s51 offen offset:896 lds
  s_add_u32 m0, s50, 68480
  s_nop 0
  buffer_load_dwordx4 v3, s[32:35], s50 offen offset:128 lds
  s_add_u32 m0, s51, 68480
  s_nop 0
  buffer_load_dwordx4 v250, s[32:35], s51 offen offset:128 lds
  s_barrier
  ds_read_b128 v[112:115], v8 offset:0
  ds_read_b128 v[120:123], v9 offset:0
  ds_read_b128 v[128:131], v10 offset:0
  ds_read_b128 v[136:139], v11 offset:0
  ds_read_b128 v[144:147], v8 offset:1024
  ds_read_b128 v[152:155], v9 offset:1024
  s_add_u32 m0, s50, 74752
  s_nop 0
  buffer_load_dwordx4 v3, s[32:35], s50 offen offset:1024 lds
  s_waitcnt lgkmcnt(0)
  v_lshlrev_b32 v108, 16, v112
  v_and_b32 v109, 0xffff0000, v112
  v_lshlrev_b32 v110, 16, v113
  v_and_b32 v111, 0xffff0000, v113
  v_lshlrev_b32 v112, 16, v114
  v_and_b32 v113, 0xffff0000, v114
  v_lshlrev_b32 v114, 16, v115
  v_and_b32 v115, 0xffff0000, v115
  s_add_u32 m0, s51, 74752
  s_nop 0
  buffer_load_dwordx4 v250, s[32:35], s51 offen offset:1024 lds
  v_lshlrev_b32 v116, 16, v120
  v_and_b32 v117, 0xffff0000, v120
  v_lshlrev_b32 v118, 16, v121
  v_and_b32 v119, 0xffff0000, v121
  v_lshlrev_b32 v120, 16, v122
  v_and_b32 v121, 0xffff0000, v122
  v_lshlrev_b32 v122, 16, v123
  v_and_b32 v123, 0xffff0000, v123
  s_add_u32 m0, s50, 69376
  s_nop 0
  buffer_load_dwordx4 v3, s[32:35], s50 offen offset:256 lds
  v_lshlrev_b32 v124, 16, v128
  v_and_b32 v125, 0xffff0000, v128
  v_lshlrev_b32 v126, 16, v129
  v_and_b32 v127, 0xffff0000, v129
  v_lshlrev_b32 v128, 16, v130
  v_and_b32 v129, 0xffff0000, v130
  v_lshlrev_b32 v130, 16, v131
  v_and_b32 v131, 0xffff0000, v131
  s_add_u32 m0, s51, 69376
  s_nop 0
  buffer_load_dwordx4 v250, s[32:35], s51 offen offset:256 lds
  v_lshlrev_b32 v132, 16, v136
  v_and_b32 v133, 0xffff0000, v136
  v_lshlrev_b32 v134, 16, v137
  v_and_b32 v135, 0xffff0000, v137
  v_lshlrev_b32 v136, 16, v138
  v_and_b32 v137, 0xffff0000, v138
  v_lshlrev_b32 v138, 16, v139
  v_and_b32 v139, 0xffff0000, v139
  s_add_u32 m0, s50, 75648
  s_nop 0
  buffer_load_dwordx4 v3, s[32:35], s50 offen offset:1152 lds
  v_lshlrev_b32 v140, 16, v144
  v_and_b32 v141, 0xffff0000, v144
  v_lshlrev_b32 v142, 16, v145
  v_and_b32 v143, 0xffff0000, v145
  v_lshlrev_b32 v144, 16, v146
  v_and_b32 v145, 0xffff0000, v146
  v_lshlrev_b32 v146, 16, v147
  v_and_b32 v147, 0xffff0000, v147
  s_add_u32 m0, s51, 75648
  s_nop 0
  buffer_load_dwordx4 v250, s[32:35], s51 offen offset:1152 lds
  v_lshlrev_b32 v148, 16, v152
  v_and_b32 v149, 0xffff0000, v152
  v_lshlrev_b32 v150, 16, v153
  v_and_b32 v151, 0xffff0000, v153
  v_lshlrev_b32 v152, 16, v154
  v_and_b32 v153, 0xffff0000, v154
  v_lshlrev_b32 v154, 16, v155
  v_and_b32 v155, 0xffff0000, v155
  s_add_u32 m0, s50, 70272
  s_nop 0
  buffer_load_dwordx4 v3, s[32:35], s50 offen offset:384 lds
  s_add_u32 m0, s51, 70272
  s_nop 0
  buffer_load_dwordx4 v250, s[32:35], s51 offen offset:384 lds
  s_add_u32 m0, s50, 76544
  s_nop 0
  buffer_load_dwordx4 v3, s[32:35], s50 offen offset:1280 lds
  s_add_u32 m0, s51, 76544
  s_nop 0
  buffer_load_dwordx4 v250, s[32:35], s51 offen offset:1280 lds
  s_add_u32 m0, s50, 71168
  s_nop 0
  buffer_load_dwordx4 v3, s[32:35], s50 offen offset:512 lds
  s_add_u32 m0, s51, 71168
  s_nop 0
  buffer_load_dwordx4 v250, s[32:35], s51 offen offset:512 lds
  s_add_u32 m0, s50, 77440
  s_nop 0
  buffer_load_dwordx4 v3, s[32:35], s50 offen offset:1408 lds
  s_add_u32 m0, s51, 77440
  s_nop 0
  buffer_load_dwordx4 v250, s[32:35], s51 offen offset:1408 lds
  s_add_u32 m0, s50, 72064
  s_nop 0
  buffer_load_dwordx4 v3, s[32:35], s50 offen offset:640 lds
  s_add_u32 m0, s51, 72064
  s_nop 0
  buffer_load_dwordx4 v250, s[32:35], s51 offen offset:640 lds
  s_add_u32 m0, s50, 78336
  s_nop 0
  buffer_load_dwordx4 v3, s[32:35], s50 offen offset:1536 lds
  s_add_u32 m0, s51, 78336
  s_nop 0
  buffer_load_dwordx4 v250, s[32:35], s51 offen offset:1536 lds
  s_waitcnt vmcnt(16) lgkmcnt(0)
  ds_read_b128 a[0:3], v232 offset:0
  ds_read_b128 a[4:7], v234 offset:0
  ds_read_b128 a[8:11], v233 offset:0
  ds_read_b128 a[12:15], v235 offset:0
  ds_read_b128 a[16:19], v232 offset:1024
  ds_read_b128 a[20:23], v234 offset:1024
  ds_read_b128 a[24:27], v233 offset:1024
  ds_read_b128 a[28:31], v235 offset:1024
  v_accvgpr_write_b32 a128, v204
  v_accvgpr_write_b32 a129, 0
  v_accvgpr_write_b32 a130, 0
  v_accvgpr_write_b32 a131, 0
  v_accvgpr_write_b32 a156, v205
  v_accvgpr_write_b32 a157, 0
  v_accvgpr_write_b32 a158, 0
  v_accvgpr_write_b32 a159, 0
  v_accvgpr_write_b32 a184, v206
  v_accvgpr_write_b32 a185, 0
  v_accvgpr_write_b32 a186, 0
  v_accvgpr_write_b32 a187, 0
  s_mul_i32 s52, s48, 9
  s_add_u32 s52, s52, 0
  s_min_u32 s52, s52, 25
  s_lshl_b32 s53, s52, 10
  s_add_u32 m0, s53, 40960
  s_lshl_b32 s53, s52, 7
  s_cmp_ge_u32 s52, 13
  s_cselect_b32 s54, 11648, 0
  s_add_u32 s53, s53, s54
  s_add_u32 s53, s53, s55
  s_add_u32 s53, s53, 26624
  buffer_load_dwordx4 v3, s[20:23], s53 offen nt lds
  s_mul_i32 s52, s48, 9
  s_add_u32 s52, s52, 1
  s_min_u32 s52, s52, 25
  s_lshl_b32 s53, s52, 10
  s_add_u32 m0, s53, 40960
  s_lshl_b32 s53, s52, 7
  s_cmp_ge_u32 s52, 13
  s_cselect_b32 s54, 11648, 0
  s_add_u32 s53, s53, s54
  s_add_u32 s53, s53, s55
  s_add_u32 s53, s53, 26624
  buffer_load_dwordx4 v3, s[20:23], s53 offen nt lds
  s_mul_i32 s52, s48, 9
  s_add_u32 s52, s52, 2
  s_min_u32 s52, s52, 25
  s_lshl_b32 s53, s52, 10
  s_add_u32 m0, s53, 40960
  s_lshl_b32 s53, s52, 7
  s_cmp_ge_u32 s52, 13
  s_cselect_b32 s54, 11648, 0
  s_add_u32 s53, s53, s54
  s_add_u32 s53, s53, s55
  s_add_u32 s53, s53, 26624
  buffer_load_dwordx4 v3, s[20:23], s53 offen nt lds
  s_mul_i32 s52, s48, 9
  s_add_u32 s52, s52, 3
  s_min_u32 s52, s52, 25
  s_lshl_b32 s53, s52, 10
  s_add_u32 m0, s53, 40960
  s_lshl_b32 s53, s52, 7
  s_cmp_ge_u32 s52, 13
  s_cselect_b32 s54, 11648, 0
  s_add_u32 s53, s53, s54
  s_add_u32 s53, s53, s55
  s_add_u32 s53, s53, 26624
  buffer_load_dwordx4 v3, s[20:23], s53 offen nt lds
  s_mul_i32 s52, s48, 9
  s_add_u32 s52, s52, 4
  s_min_u32 s52, s52, 25
  s_lshl_b32 s53, s52, 10
  s_add_u32 m0, s53, 40960
  s_lshl_b32 s53, s52, 7
  s_cmp_ge_u32 s52, 13
  s_cselect_b32 s54, 11648, 0
  s_add_u32 s53, s53, s54
  s_add_u32 s53, s53, s55
  s_add_u32 s53, s53, 26624
  buffer_load_dwordx4 v3, s[20:23], s53 offen nt lds
  s_mul_i32 s52, s48, 9
  s_add_u32 s52, s52, 5
  s_min_u32 s52, s52, 25
  s_lshl_b32 s53, s52, 10
  s_add_u32 m0, s53, 40960
  s_lshl_b32 s53, s52, 7
  s_cmp_ge_u32 s52, 13
  s_cselect_b32 s54, 11648, 0
  s_add_u32 s53, s53, s54
  s_add_u32 s53, s53, s55
  s_add_u32 s53, s53, 26624
  buffer_load_dwordx4 v3, s[20:23], s53 offen nt lds
  s_mul_i32 s52, s48, 9
  s_add_u32 s52, s52, 6
  s_min_u32 s52, s52, 25
  s_lshl_b32 s53, s52, 10
  s_add_u32 m0, s53, 40960
  s_lshl_b32 s53, s52, 7
  s_cmp_ge_u32 s52, 13
  s_cselect_b32 s54, 11648, 0
  s_add_u32 s53, s53, s54
  s_add_u32 s53, s53, s55
  s_add_u32 s53, s53, 26624
  buffer_load_dwordx4 v3, s[20:23], s53 offen nt lds
  s_mul_i32 s52, s48, 9
  s_add_u32 s52, s52, 7
  s_min_u32 s52, s52, 25
  s_lshl_b32 s53, s52, 10
  s_add_u32 m0, s53, 40960
  s_lshl_b32 s53, s52, 7
  s_cmp_ge_u32 s52, 13
  s_cselect_b32 s54, 11648, 0
  s_add_u32 s53, s53, s54
  s_add_u32 s53, s53, s55
  s_add_u32 s53, s53, 26624
  buffer_load_dwordx4 v3, s[20:23], s53 offen nt lds
  s_mul_i32 s52, s48, 9
  s_add_u32 s52, s52, 8
  s_min_u32 s52, s52, 25
  s_lshl_b32 s53, s52, 10
  s_add_u32 m0, s53, 40960
  s_lshl_b32 s53, s52, 7
  s_cmp_ge_u32 s52, 13
  s_cselect_b32 s54, 11648, 0
  s_add_u32 s53, s53, s54
  s_add_u32 s53, s53, s55
  s_add_u32 s53, s53, 26624
  buffer_load_dwordx4 v3, s[20:23], s53 offen nt lds
  s_waitcnt vmcnt(15) lgkmcnt(0)
  ds_read_b128 a[32:35], v232 offset:2048
  ds_read_b128 a[36:39], v234 offset:2048
  ds_read_b128 a[40:43], v233 offset:2048
  ds_read_b128 a[44:47], v235 offset:2048
  ds_read_b128 a[48:51], v232 offset:3072
  ds_read_b128 a[52:55], v234 offset:3072
  ds_read_b128 a[56:59], v233 offset:3072
  ds_read_b128 a[60:63], v235 offset:3072
  ds_read_b128 a[64:67], v232 offset:4096
  ds_read_b128 a[68:71], v234 offset:4096
  s_waitcnt vmcnt(11)
  ds_read_b128 a[72:75], v233 offset:4096
  ds_read_b128 a[76:79], v235 offset:4096
  ds_read_b128 a[80:83], v232 offset:5120
  ds_read_b128 a[84:87], v234 offset:5120
  s_waitcnt vmcnt(9) lgkmcnt(10)
  ds_read_b128 a[88:91], v233 offset:5120
  ds_read_b128 a[92:95], v235 offset:5120
  ds_read_b128 a[96:99], v232 offset:6144
  ds_read_b128 a[100:103], v234 offset:6144
  s_mul_i32 s54, s48, 19968
  s_mul_i32 s55, s48, 20480
  s_add_u32 s55, s55, 67584
  s_waitcnt lgkmcnt(0)
  s_barrier
  ds_read_b128 a[188:191], v4 offset:0
  ds_read_b128 a[192:195], v4 offset:13312
  ds_read_b128 a[196:199], v5 offset:0
  ds_read_b128 a[200:203], v5 offset:13312
  ds_read_b128 a[204:207], v4 offset:1024
  ds_read_b128 a[208:211], v4 offset:14336
  s_waitcnt lgkmcnt(5)
  v_mfma_f32_16x16x32_bf16 v[204:207], a[0:3], a[188:191], 0
  ds_read_b128 a[212:215], v5 offset:1024
  v_mfma_f32_16x16x32_bf16 v[208:211], a[4:7], a[188:191], 0
  s_waitcnt lgkmcnt(5)
  v_mfma_f32_16x16x32_bf16 v[212:215], a[0:3], a[192:195], 0
  ds_read_b128 a[216:219], v5 offset:14336
  v_mfma_f32_16x16x32_bf16 v[216:219], a[4:7], a[192:195], 0
  s_waitcnt lgkmcnt(5)
  v_mfma_f32_16x16x32_bf16 v[204:207], a[8:11], a[196:199], v[204:207]
  ds_read_b128 a[188:191], v4 offset:2048
  v_mfma_f32_16x16x32_bf16 v[208:211], a[12:15], a[196:199], v[208:211]
  s_waitcnt lgkmcnt(5)
  v_mfma_f32_16x16x32_bf16 v[212:215], a[8:11], a[200:203], v[212:215]
  ds_read_b128 a[192:195], v4 offset:15360
  v_mfma_f32_16x16x32_bf16 v[216:219], a[12:15], a[200:203], v[216:219]
  s_waitcnt lgkmcnt(5)
  v_mfma_f32_16x16x32_bf16 v[204:207], a[16:19], a[204:207], v[204:207]
  ds_read_b128 a[196:199], v5 offset:2048
  v_mfma_f32_16x16x32_bf16 v[208:211], a[20:23], a[204:207], v[208:211]
  s_waitcnt lgkmcnt(5)
  v_mfma_f32_16x16x32_bf16 v[212:215], a[16:19], a[208:211], v[212:215]
  ds_read_b128 a[200:203], v5 offset:15360
  v_mfma_f32_16x16x32_bf16 v[216:219], a[20:23], a[208:211], v[216:219]
  s_waitcnt lgkmcnt(5)
  v_mfma_f32_16x16x32_bf16 v[204:207], a[24:27], a[212:215], v[204:207]
  ds_read_b128 a[204:207], v4 offset:3072
  v_mfma_f32_16x16x32_bf16 v[208:211], a[28:31], a[212:215], v[208:211]
  s_waitcnt lgkmcnt(5)
  v_mfma_f32_16x16x32_bf16 v[212:215], a[24:27], a[216:219], v[212:215]
  ds_read_b128 a[208:211], v4 offset:16384
  v_mfma_f32_16x16x32_bf16 v[216:219], a[28:31], a[216:219], v[216:219]
  s_waitcnt lgkmcnt(5)
  v_mfma_f32_16x16x32_bf16 v[204:207], a[32:35], a[188:191], v[204:207]
  ds_read_b128 a[212:215], v5 offset:3072
  v_mfma_f32_16x16x32_bf16 v[208:211], a[36:39], a[188:191], v[208:211]
  s_waitcnt lgkmcnt(5)
  v_mfma_f32_16x16x32_bf16 v[212:215], a[32:35], a[192:195], v[212:215]
  ds_read_b128 a[216:219], v5 offset:16384
  v_mfma_f32_16x16x32_bf16 v[216:219], a[36:39], a[192:195], v[216:219]
  s_waitcnt lgkmcnt(5)
  v_mfma_f32_16x16x32_bf16 v[204:207], a[40:43], a[196:199], v[204:207]
  ds_read_b128 a[188:191], v4 offset:4096
  v_mfma_f32_16x16x32_bf16 v[208:211], a[44:47], a[196:199], v[208:211]
  s_waitcnt lgkmcnt(5)
  v_mfma_f32_16x16x32_bf16 v[212:215], a[40:43], a[200:203], v[212:215]
  ds_read_b128 a[192:195], v4 offset:17408
  v_mfma_f32_16x16x32_bf16 v[216:219], a[44:47], a[200:203], v[216:219]
  s_waitcnt lgkmcnt(5)
  v_mfma_f32_16x16x32_bf16 v[204:207], a[48:51], a[204:207], v[204:207]
  ds_read_b128 a[196:199], v5 offset:4096
  v_mfma_f32_16x16x32_bf16 v[208:211], a[52:55], a[204:207], v[208:211]
  s_waitcnt lgkmcnt(5)
  v_mfma_f32_16x16x32_bf16 v[212:215], a[48:51], a[208:211], v[212:215]
  ds_read_b128 a[200:203], v5 offset:17408
  v_mfma_f32_16x16x32_bf16 v[216:219], a[52:55], a[208:211], v[216:219]
  s_waitcnt lgkmcnt(5)
  v_mfma_f32_16x16x32_bf16 v[204:207], a[56:59], a[212:215], v[204:207]
  ds_read_b128 a[204:207], v4 offset:5120
  v_mfma_f32_16x16x32_bf16 v[208:211], a[60:63], a[212:215], v[208:211]
  s_waitcnt lgkmcnt(5)
  v_mfma_f32_16x16x32_bf16 v[212:215], a[56:59], a[216:219], v[212:215]
  ds_read_b128 a[208:211], v4 offset:18432
  v_mfma_f32_16x16x32_bf16 v[216:219], a[60:63], a[216:219], v[216:219]
  s_waitcnt lgkmcnt(5)
  v_mfma_f32_16x16x32_bf16 v[204:207], a[64:67], a[188:191], v[204:207]
  ds_read_b128 a[212:215], v5 offset:5120
  v_mfma_f32_16x16x32_bf16 v[208:211], a[68:71], a[188:191], v[208:211]
  s_waitcnt lgkmcnt(5)
  v_mfma_f32_16x16x32_bf16 v[212:215], a[64:67], a[192:195], v[212:215]
  ds_read_b128 a[216:219], v5 offset:18432
  v_mfma_f32_16x16x32_bf16 v[216:219], a[68:71], a[192:195], v[216:219]
  s_waitcnt lgkmcnt(5)
  v_mfma_f32_16x16x32_bf16 v[204:207], a[72:75], a[196:199], v[204:207]
  ds_read_b128 a[188:191], v4 offset:6144
  v_mfma_f32_16x16x32_bf16 v[208:211], a[76:79], a[196:199], v[208:211]
  s_waitcnt lgkmcnt(5)
  v_mfma_f32_16x16x32_bf16 v[212:215], a[72:75], a[200:203], v[212:215]
  s_add_u32 m0, s55, 0
  s_nop 0
  buffer_load_dwordx4 v0, s[36:39], s54 offen lds
  ds_read_b128 a[192:195], v4 offset:19456
  v_mfma_f32_16x16x32_bf16 v[216:219], a[76:79], a[200:203], v[216:219]
  buffer_load_dwordx4 v0, s[36:39], s54 offen offset:1024 lds
  s_waitcnt lgkmcnt(5)
  v_mfma_f32_16x16x32_bf16 v[204:207], a[80:83], a[204:207], v[204:207]
  buffer_load_dwordx4 v0, s[36:39], s54 offen offset:2048 lds
  v_mfma_f32_16x16x32_bf16 v[208:211], a[84:87], a[204:207], v[208:211]
  buffer_load_dwordx4 v0, s[36:39], s54 offen offset:3072 lds
  s_waitcnt lgkmcnt(4)
  v_mfma_f32_16x16x32_bf16 v[212:215], a[80:83], a[208:211], v[212:215]
  s_add_u32 s54, s54, 4096
  s_add_u32 m0, s55, 4096
  s_nop 0
  buffer_load_dwordx4 v0, s[36:39], s54 offen lds
  v_mfma_f32_16x16x32_bf16 v[216:219], a[84:87], a[208:211], v[216:219]
  buffer_load_dwordx4 v0, s[36:39], s54 offen offset:1024 lds
  s_waitcnt lgkmcnt(3)
  v_mfma_f32_16x16x32_bf16 v[204:207], a[88:91], a[212:215], v[204:207]
  buffer_load_dwordx4 v0, s[36:39], s54 offen offset:2048 lds
  v_mfma_f32_16x16x32_bf16 v[208:211], a[92:95], a[212:215], v[208:211]
  buffer_load_dwordx4 v0, s[36:39], s54 offen offset:3072 lds
  s_waitcnt lgkmcnt(2)
  v_mfma_f32_16x16x32_bf16 v[212:215], a[88:91], a[216:219], v[212:215]
  s_add_u32 s54, s54, 4096
  s_add_u32 m0, s55, 8192
  s_nop 0
  buffer_load_dwordx4 v0, s[36:39], s54 offen lds
  v_mfma_f32_16x16x32_bf16 v[216:219], a[92:95], a[216:219], v[216:219]
  s_waitcnt lgkmcnt(1)
  v_mfma_f32_16x16x32_bf16 v[204:207], a[96:99], a[188:191], v[204:207]
  s_waitcnt vmcnt(9)
  s_barrier
  v_mfma_f32_16x16x32_bf16 v[208:211], a[100:103], a[188:191], v[208:211]
  ds_read_b128 a[196:199], v4 offset:26624
  ds_read_b128 a[200:203], v4 offset:39936
  ds_read_b128 a[204:207], v5 offset:26624
  ds_read_b128 a[208:211], v5 offset:39936
  ds_read_b128 a[212:215], v4 offset:27648
  ds_read_b128 v[160:163], v8 offset:26624
  ds_read_b128 v[168:171], v9 offset:26624
  s_waitcnt lgkmcnt(7)
  v_mfma_f32_16x16x32_bf16 v[212:215], a[96:99], a[192:195], v[212:215]
  ds_read_b128 a[216:219], v4 offset:40960
  v_mfma_f32_16x16x32_bf16 v[216:219], a[100:103], a[192:195], v[216:219]
  s_waitcnt lgkmcnt(2)
  v_mfma_f32_16x16x32_bf16 v[220:223], a[0:3], a[196:199], 0
  buffer_load_dwordx4 v0, s[36:39], s54 offen offset:1024 lds
  ds_read_b128 a[188:191], v5 offset:27648
  v_lshlrev_b32 v156, 16, v160
  v_mfma_f32_16x16x32_bf16 v[224:227], a[4:7], a[196:199], 0
  v_cvt_pk_bf16_f32 v204, v204, v205
  v_cvt_pk_bf16_f32 v205, v206, v207
  v_and_b32 v157, 0xffff0000, v160
  v_mfma_f32_16x16x32_bf16 v[228:231], a[0:3], a[200:203], 0
  buffer_load_dwordx4 v0, s[36:39], s54 offen offset:2048 lds
  ds_read_b128 a[192:195], v5 offset:40960
  v_lshlrev_b32 v158, 16, v161
  v_mfma_f32_16x16x32_bf16 v[232:235], a[4:7], a[200:203], 0
  v_cvt_pk_bf16_f32 v206, v208, v209
  v_cvt_pk_bf16_f32 v207, v210, v211
  v_and_b32 v159, 0xffff0000, v161
  v_mfma_f32_16x16x32_bf16 v[220:223], a[8:11], a[204:207], v[220:223]
  buffer_load_dwordx4 v0, s[36:39], s54 offen offset:3072 lds
  ds_read_b128 a[196:199], v4 offset:28672
  v_lshlrev_b32 v160, 16, v162
  v_mfma_f32_16x16x32_bf16 v[224:227], a[12:15], a[204:207], v[224:227]
  v_cvt_pk_bf16_f32 v212, v212, v213
  v_cvt_pk_bf16_f32 v213, v214, v215
  v_and_b32 v161, 0xffff0000, v162
  v_mfma_f32_16x16x32_bf16 v[228:231], a[8:11], a[208:211], v[228:231]
  s_add_u32 s54, s54, 4096
  s_add_u32 m0, s55, 12288
  s_nop 0
  buffer_load_dwordx4 v0, s[36:39], s54 offen lds
  ds_read_b128 a[200:203], v4 offset:41984
  v_lshlrev_b32 v162, 16, v163
  v_mfma_f32_16x16x32_bf16 v[232:235], a[12:15], a[208:211], v[232:235]
  v_cvt_pk_bf16_f32 v214, v216, v217
  v_cvt_pk_bf16_f32 v215, v218, v219
  v_and_b32 v163, 0xffff0000, v163
  v_mfma_f32_16x16x32_bf16 v[220:223], a[16:19], a[212:215], v[220:223]
  buffer_load_dwordx4 v0, s[36:39], s54 offen offset:1024 lds
  ds_read_b128 a[204:207], v5 offset:28672
  s_waitcnt lgkmcnt(5)
  v_lshlrev_b32 v164, 16, v168
  v_mfma_f32_16x16x32_bf16 v[224:227], a[20:23], a[212:215], v[224:227]
  v_and_b32 v165, 0xffff0000, v168
  v_lshlrev_b32 v166, 16, v169
  v_and_b32 v167, 0xffff0000, v169
  v_mfma_f32_16x16x32_bf16 v[228:231], a[16:19], a[216:219], v[228:231]
  buffer_load_dwordx4 v0, s[36:39], s54 offen offset:2048 lds
  ds_read_b128 a[208:211], v5 offset:41984
  v_lshlrev_b32 v168, 16, v170
  v_mfma_f32_16x16x32_bf16 v[232:235], a[20:23], a[216:219], v[232:235]
  v_and_b32 v169, 0xffff0000, v170
  v_lshlrev_b32 v170, 16, v171
  v_and_b32 v171, 0xffff0000, v171
  ds_read_b128 v[176:179], v10 offset:26624
  ds_read_b128 v[184:187], v11 offset:26624
  s_waitcnt lgkmcnt(7)
  v_mfma_f32_16x16x32_bf16 v[220:223], a[24:27], a[188:191], v[220:223]
  buffer_load_dwordx4 v0, s[36:39], s54 offen offset:3072 lds
  ds_read_b128 a[212:215], v4 offset:29696
  v_mfma_f32_16x16x32_bf16 v[224:227], a[28:31], a[188:191], v[224:227]
  s_waitcnt lgkmcnt(2)
  v_mfma_f32_16x16x32_bf16 v[228:231], a[24:27], a[192:195], v[228:231]
  s_add_u32 s54, s54, 4096
  s_add_u32 m0, s55, 16384
  s_nop 0
  buffer_load_dwordx4 v0, s[36:39], s54 offen lds
  ds_read_b128 a[216:219], v4 offset:43008
  v_lshlrev_b32 v172, 16, v176
  v_mfma_f32_16x16x32_bf16 v[232:235], a[28:31], a[192:195], v[232:235]
  v_and_b32 v173, 0xffff0000, v176
  v_lshlrev_b32 v174, 16, v177
  v_and_b32 v175, 0xffff0000, v177
  v_mfma_f32_16x16x32_bf16 v[220:223], a[32:35], a[196:199], v[220:223]
  buffer_load_dwordx4 v0, s[36:39], s54 offen offset:1024 lds
  ds_read_b128 a[188:191], v5 offset:29696
  v_lshlrev_b32 v176, 16, v178
  v_mfma_f32_16x16x32_bf16 v[224:227], a[36:39], a[196:199], v[224:227]
  v_and_b32 v177, 0xffff0000, v178
  v_lshlrev_b32 v178, 16, v179
  v_and_b32 v179, 0xffff0000, v179
  v_mfma_f32_16x16x32_bf16 v[228:231], a[32:35], a[200:203], v[228:231]
  buffer_load_dwordx4 v0, s[36:39], s54 offen offset:2048 lds
  ds_read_b128 a[192:195], v5 offset:43008
  s_waitcnt lgkmcnt(4)
  v_lshlrev_b32 v180, 16, v184
  v_mfma_f32_16x16x32_bf16 v[232:235], a[36:39], a[200:203], v[232:235]
  v_and_b32 v181, 0xffff0000, v184
  v_lshlrev_b32 v182, 16, v185
  v_and_b32 v183, 0xffff0000, v185
  v_mfma_f32_16x16x32_bf16 v[220:223], a[40:43], a[204:207], v[220:223]
  buffer_load_dwordx4 v0, s[36:39], s54 offen offset:3072 lds
  ds_read_b128 a[196:199], v4 offset:30720
  v_lshlrev_b32 v184, 16, v186
  v_mfma_f32_16x16x32_bf16 v[224:227], a[44:47], a[204:207], v[224:227]
  v_and_b32 v185, 0xffff0000, v186
  v_lshlrev_b32 v186, 16, v187
  v_and_b32 v187, 0xffff0000, v187
  ds_read_b128 v[192:195], v8 offset:27648
  ds_read_b128 v[200:203], v9 offset:27648
  v_mfma_f32_16x16x32_bf16 v[228:231], a[40:43], a[208:211], v[228:231]
  ds_read_b128 a[200:203], v4 offset:44032
  v_mfma_f32_16x16x32_bf16 v[232:235], a[44:47], a[208:211], v[232:235]
  s_waitcnt lgkmcnt(2)
  v_mfma_f32_16x16x32_bf16 v[220:223], a[48:51], a[212:215], v[220:223]
  ds_read_b128 a[204:207], v5 offset:30720
  v_lshlrev_b32 v188, 16, v192
  v_and_b32 v189, 0xffff0000, v192
  v_mfma_f32_16x16x32_bf16 v[224:227], a[52:55], a[212:215], v[224:227]
  v_lshlrev_b32 v190, 16, v193
  v_and_b32 v191, 0xffff0000, v193
  v_lshlrev_b32 v192, 16, v194
  v_mfma_f32_16x16x32_bf16 v[228:231], a[48:51], a[216:219], v[228:231]
  ds_read_b128 a[208:211], v5 offset:44032
  v_and_b32 v193, 0xffff0000, v194
  v_lshlrev_b32 v194, 16, v195
  v_mfma_f32_16x16x32_bf16 v[232:235], a[52:55], a[216:219], v[232:235]
  v_and_b32 v195, 0xffff0000, v195
  s_waitcnt lgkmcnt(3)
  v_lshlrev_b32 v196, 16, v200
  v_and_b32 v197, 0xffff0000, v200
  v_mfma_f32_16x16x32_bf16 v[220:223], a[56:59], a[188:191], v[220:223]
  ds_read_b128 a[212:215], v4 offset:31744
  v_lshlrev_b32 v198, 16, v201
  v_and_b32 v199, 0xffff0000, v201
  v_mfma_f32_16x16x32_bf16 v[224:227], a[60:63], a[188:191], v[224:227]
  v_lshlrev_b32 v200, 16, v202
  v_and_b32 v201, 0xffff0000, v202
  v_lshlrev_b32 v202, 16, v203
  v_mfma_f32_16x16x32_bf16 v[228:231], a[56:59], a[192:195], v[228:231]
  ds_read_b128 a[216:219], v4 offset:45056
  v_and_b32 v203, 0xffff0000, v203
  v_mfma_f32_16x16x32_bf16 v[232:235], a[60:63], a[192:195], v[232:235]
  v_mfma_f32_16x16x32_bf16 v[220:223], a[64:67], a[196:199], v[220:223]
  ds_read_b128 a[188:191], v5 offset:31744
  v_mfma_f32_16x16x32_bf16 v[224:227], a[68:71], a[196:199], v[224:227]
  s_waitcnt lgkmcnt(5)
  v_mfma_f32_16x16x32_bf16 v[228:231], a[64:67], a[200:203], v[228:231]
  ds_read_b128 a[192:195], v5 offset:45056
  v_mfma_f32_16x16x32_bf16 v[232:235], a[68:71], a[200:203], v[232:235]
  s_waitcnt lgkmcnt(5)
  v_mfma_f32_16x16x32_bf16 v[220:223], a[72:75], a[204:207], v[220:223]
  ds_read_b128 a[196:199], v4 offset:32768
  v_mfma_f32_16x16x32_bf16 v[224:227], a[76:79], a[204:207], v[224:227]
  s_waitcnt vmcnt(13)
  ds_read_b128 a[104:107], v249 offset:0
  ds_read_b128 a[108:111], v249 offset:32
  ds_read_b128 a[112:115], v249 offset:64
  ds_read_b128 a[116:119], v249 offset:96
  ds_read_b128 a[120:123], v249 offset:128
  ds_read_b128 a[124:127], v249 offset:160
  s_mov_b32 exec_hi, 0
  ds_read_b128 a[128:131], v249 offset:192
  s_mov_b32 exec_hi, -1
  s_waitcnt lgkmcnt(12)
  v_mfma_f32_16x16x32_bf16 v[228:231], a[72:75], a[208:211], v[228:231]
  ds_read_b128 a[200:203], v4 offset:46080
  v_mfma_f32_16x16x32_bf16 v[232:235], a[76:79], a[208:211], v[232:235]
  s_waitcnt lgkmcnt(12)
  v_mfma_f32_16x16x32_bf16 v[220:223], a[80:83], a[212:215], v[220:223]
  v_mfma_f32_16x16x32_bf16 v[224:227], a[84:87], a[212:215], v[224:227]
  s_waitcnt lgkmcnt(11)
  v_mfma_f32_16x16x32_bf16 v[228:231], a[80:83], a[216:219], v[228:231]
  v_mfma_f32_16x16x32_bf16 v[232:235], a[84:87], a[216:219], v[232:235]
  s_waitcnt vmcnt(7)
  ds_read_b128 a[132:135], v249 offset:6656
  ds_read_b128 a[136:139], v249 offset:6688
  ds_read_b128 a[140:143], v249 offset:6720
  ds_read_b128 a[144:147], v249 offset:6752
  s_waitcnt lgkmcnt(14)
  ds_read_b128 a[148:151], v249 offset:6784
  s_waitcnt lgkmcnt(14)
  ds_read_b128 a[152:155], v249 offset:6816
  s_mov_b32 exec_hi, 0
  s_waitcnt lgkmcnt(14)
  ds_read_b128 a[156:159], v249 offset:6848
  s_mov_b32 exec_hi, -1
  v_mfma_f32_16x16x32_bf16 v[220:223], a[88:91], a[188:191], v[220:223]
  v_mfma_f32_16x16x32_bf16 v[224:227], a[92:95], a[188:191], v[224:227]
  v_mfma_f32_16x16x32_bf16 v[228:231], a[88:91], a[192:195], v[228:231]
  v_mfma_f32_16x16x32_bf16 v[232:235], a[92:95], a[192:195], v[232:235]
  v_mfma_f32_16x16x32_bf16 v[220:223], a[96:99], a[196:199], v[220:223]
  v_mfma_f32_16x16x32_bf16 v[224:227], a[100:103], a[196:199], v[224:227]
  s_waitcnt vmcnt(0) lgkmcnt(14)
  ds_read_b128 a[160:163], v249 offset:13312
  s_waitcnt lgkmcnt(14)
  ds_read_b128 a[164:167], v249 offset:13344
  s_waitcnt lgkmcnt(14)
  ds_read_b128 a[168:171], v249 offset:13376
  s_waitcnt lgkmcnt(14)
  ds_read_b128 a[172:175], v249 offset:13408
  s_waitcnt lgkmcnt(14)
  ds_read_b128 a[176:179], v249 offset:13440
  s_waitcnt lgkmcnt(14)
  ds_read_b128 a[180:183], v249 offset:13472
  s_mov_b32 exec_hi, 0
  s_waitcnt lgkmcnt(14)
  ds_read_b128 a[184:187], v249 offset:13504
  s_mov_b32 exec_hi, -1
  s_waitcnt lgkmcnt(14)
  ds_write_b128 v2, v[204:207] offset:0
  s_waitcnt lgkmcnt(14)
  ds_write_b128 v2, v[212:215] offset:256
  v_mfma_f32_16x16x32_bf16 v[228:231], a[96:99], a[200:203], v[228:231]
  s_waitcnt lgkmcnt(0)
  s_barrier
  v_mfma_f32_16x16x32_bf16 v[232:235], a[100:103], a[200:203], v[232:235]
  s_add_u32 s28, s28, 175232
  s_addc_u32 s29, s29, 0
  s_sub_u32 s30, s30, 175232
  buffer_load_dwordx4 a[0:3], v0, s[28:31], 0 offen sc1
  buffer_load_dwordx4 a[4:7], v0, s[28:31], s62 offen offset:1024 sc1
  buffer_load_dwordx4 a[8:11], v0, s[28:31], 0 offen offset:1024 sc1
  buffer_load_dwordx4 a[12:15], v0, s[28:31], s62 offen offset:2048 sc1
  buffer_load_dwordx4 a[16:19], v0, s[28:31], 0 offen offset:2048 sc1
  buffer_load_dwordx4 a[20:23], v0, s[28:31], s62 offen offset:3072 sc1
  ds_read_b128 a[220:223], v0 offset:0
  ds_read_b128 a[224:227], v0 offset:1024
  ds_read_b128 a[228:231], v0 offset:2048
  ds_read_b128 a[232:235], v0 offset:3072
  ds_read_b128 a[236:239], v0 offset:4096
  ds_read_b128 a[240:243], v0 offset:5120
standalone__cross_network_dcn_v2__recsys_kernel_loopM:
  s_waitcnt vmcnt(23) lgkmcnt(4)
  v_mfma_f32_32x32x16_bf16 v[12:27], a[104:107], a[220:223], v[12:27]
  buffer_load_dwordx4 a[24:27], v0, s[28:31], 0 offen offset:3072 sc1
  ds_read_b128 a[244:247], v0 offset:6144
  v_mfma_f32_32x32x16_bf16 v[12:27], a[108:111], a[224:227], v[12:27]
  v_cvt_pk_bf16_f32 v220, v220, v221
  v_cvt_pk_bf16_f32 v221, v222, v223
  v_cvt_pk_bf16_f32 v222, v224, v225
  v_cvt_pk_bf16_f32 v223, v226, v227
  s_waitcnt lgkmcnt(3)
  v_mfma_f32_32x32x16_bf16 v[12:27], a[112:115], a[228:231], v[12:27]
  buffer_load_dwordx4 a[28:31], v0, s[28:31], s63 offen sc1
  ds_write_b128 v2, v[220:223] offset:7168
  v_cvt_pk_bf16_f32 v228, v228, v229
  v_cvt_pk_bf16_f32 v229, v230, v231
  v_mfma_f32_32x32x16_bf16 v[12:27], a[116:119], a[232:235], v[12:27]
  v_cvt_pk_bf16_f32 v230, v232, v233
  v_cvt_pk_bf16_f32 v231, v234, v235
  ds_write_b128 v2, v[228:231] offset:7424
  s_waitcnt vmcnt(21) lgkmcnt(3)
  v_mfma_f32_32x32x16_bf16 v[12:27], a[120:123], a[236:239], v[12:27]
  buffer_load_dwordx4 a[32:35], v0, s[28:31], s60 offen sc1
  v_mfma_f32_32x32x16_bf16 v[12:27], a[124:127], a[240:243], v[12:27]
  s_waitcnt lgkmcnt(2)
  v_mfma_f32_32x32x16_bf16 v[12:27], a[128:131], a[244:247], v[12:27]
  buffer_load_dwordx4 a[36:39], v0, s[28:31], s63 offen offset:1024 sc1
  v_mfma_f32_32x32x16_bf16 v[28:43], a[132:135], a[220:223], v[28:43]
  s_waitcnt vmcnt(19)
  v_mfma_f32_32x32x16_bf16 v[28:43], a[136:139], a[224:227], v[28:43]
  buffer_load_dwordx4 a[40:43], v0, s[28:31], s60 offen offset:1024 sc1
  s_nop 7
  v_mul_f32 v244, v108, v12
  v_mul_f32 v245, v109, v13
  v_cvt_pk_bf16_f32 v236, v244, v245
  v_mul_f32 v246, v110, v14
  v_mfma_f32_32x32x16_bf16 v[28:43], a[140:143], a[228:231], v[28:43]
  v_mul_f32 v247, v111, v15
  v_cvt_pk_bf16_f32 v237, v246, v247
  v_mul_f32 v244, v112, v16
  v_mul_f32 v245, v113, v17
  v_cvt_pk_bf16_f32 v238, v244, v245
  s_waitcnt lgkmcnt(0)
  s_barrier
  v_mfma_f32_32x32x16_bf16 v[28:43], a[144:147], a[232:235], v[28:43]
  buffer_load_dwordx4 a[44:47], v0, s[28:31], s63 offen offset:2048 sc1
  v_mul_f32 v246, v114, v18
  v_mul_f32 v247, v115, v19
  v_cvt_pk_bf16_f32 v239, v246, v247
  v_mul_f32 v244, v116, v20
  v_mfma_f32_32x32x16_bf16 v[28:43], a[148:151], a[236:239], v[28:43]
  ds_write_b128 v8, v[236:239] offset:0
  v_mul_f32 v245, v117, v21
  s_waitcnt vmcnt(17)
  v_mfma_f32_32x32x16_bf16 v[28:43], a[152:155], a[240:243], v[28:43]
  buffer_load_dwordx4 a[48:51], v0, s[28:31], s60 offen offset:2048 sc1
  v_cvt_pk_bf16_f32 v240, v244, v245
  v_mul_f32 v246, v118, v22
  v_mul_f32 v247, v119, v23
  v_cvt_pk_bf16_f32 v241, v246, v247
  v_mfma_f32_32x32x16_bf16 v[28:43], a[156:159], a[244:247], v[28:43]
  v_mul_f32 v244, v120, v24
  v_mul_f32 v245, v121, v25
  v_cvt_pk_bf16_f32 v242, v244, v245
  v_mul_f32 v246, v122, v26
  v_mul_f32 v247, v123, v27
  v_mfma_f32_32x32x16_bf16 v[44:59], a[160:163], a[220:223], v[44:59]
  buffer_load_dwordx4 a[52:55], v0, s[28:31], s63 offen offset:3072 sc1
  ds_read_b128 a[220:223], v0 offset:7168
  v_cvt_pk_bf16_f32 v243, v246, v247
  v_mfma_f32_32x32x16_bf16 v[44:59], a[164:167], a[224:227], v[44:59]
  ds_read_b128 a[224:227], v0 offset:8192
  ds_write_b128 v9, v[240:243] offset:0
  s_waitcnt vmcnt(15)
  v_mfma_f32_32x32x16_bf16 v[44:59], a[168:171], a[228:231], v[44:59]
  buffer_load_dwordx4 a[56:59], v0, s[28:31], s60 offen offset:3072 sc1
  ds_read_b128 a[228:231], v0 offset:9216
  v_mul_f32 v244, v124, v28
  v_mul_f32 v245, v125, v29
  v_cvt_pk_bf16_f32 v236, v244, v245
  v_mfma_f32_32x32x16_bf16 v[44:59], a[172:175], a[232:235], v[44:59]
  ds_read_b128 a[232:235], v0 offset:10240
  v_mul_f32 v246, v126, v30
  v_mul_f32 v247, v127, v31
  v_cvt_pk_bf16_f32 v237, v246, v247
  v_mul_f32 v244, v128, v32
  v_mfma_f32_32x32x16_bf16 v[44:59], a[176:179], a[236:239], v[44:59]
  buffer_load_dwordx4 a[60:63], v0, s[28:31], s64 offen sc1
  ds_read_b128 a[236:239], v0 offset:11264
  v_mul_f32 v245, v129, v33
  v_cvt_pk_bf16_f32 v238, v244, v245
  v_mul_f32 v246, v130, v34
  v_mfma_f32_32x32x16_bf16 v[44:59], a[180:183], a[240:243], v[44:59]
  ds_read_b128 a[240:243], v0 offset:12288
  v_mul_f32 v247, v131, v35
  v_cvt_pk_bf16_f32 v239, v246, v247
  v_mul_f32 v244, v132, v36
  v_mul_f32 v245, v133, v37
  s_waitcnt vmcnt(16)
  v_mfma_f32_32x32x16_bf16 v[44:59], a[184:187], a[244:247], v[44:59]
  buffer_load_dwordx4 a[64:67], v0, s[28:31], s61 offen sc1
  ds_read_b128 a[244:247], v0 offset:13312
  v_cvt_pk_bf16_f32 v240, v244, v245
  v_mul_f32 v246, v134, v38
  v_mul_f32 v247, v135, v39
  s_waitcnt lgkmcnt(6)
  v_mfma_f32_32x32x16_bf16 v[60:75], a[104:107], a[220:223], v[60:75]
  ds_write_b128 v10, v[236:239] offset:0
  v_cvt_pk_bf16_f32 v241, v246, v247
  v_mfma_f32_32x32x16_bf16 v[60:75], a[108:111], a[224:227], v[60:75]
  buffer_load_dwordx4 a[68:71], v0, s[28:31], s64 offen offset:1024 sc1
  v_mul_f32 v244, v136, v40
  v_mul_f32 v245, v137, v41
  v_cvt_pk_bf16_f32 v242, v244, v245
  v_mul_f32 v246, v138, v42
  s_waitcnt lgkmcnt(4)
  v_mfma_f32_32x32x16_bf16 v[60:75], a[112:115], a[228:231], v[60:75]
  v_mul_f32 v247, v139, v43
  v_cvt_pk_bf16_f32 v243, v246, v247
  v_mul_f32 v244, v140, v44
  v_mul_f32 v245, v141, v45
  v_cvt_pk_bf16_f32 v236, v244, v245
  v_mfma_f32_32x32x16_bf16 v[60:75], a[116:119], a[232:235], v[60:75]
  buffer_load_dwordx4 a[72:75], v0, s[28:31], s61 offen offset:1024 sc1
  ds_write_b128 v11, v[240:243] offset:0
  s_waitcnt lgkmcnt(3)
  v_mfma_f32_32x32x16_bf16 v[60:75], a[120:123], a[236:239], v[60:75]
  v_mul_f32 v246, v142, v46
  v_mul_f32 v247, v143, v47
  v_cvt_pk_bf16_f32 v237, v246, v247
  v_mul_f32 v244, v144, v48
  v_mul_f32 v245, v145, v49
  v_mfma_f32_32x32x16_bf16 v[60:75], a[124:127], a[240:243], v[60:75]
  buffer_load_dwordx4 a[76:79], v0, s[28:31], s64 offen offset:2048 sc1
  v_cvt_pk_bf16_f32 v238, v244, v245
  v_mul_f32 v246, v146, v50
  v_mul_f32 v247, v147, v51
  v_cvt_pk_bf16_f32 v239, v246, v247
  s_waitcnt lgkmcnt(2)
  v_mfma_f32_32x32x16_bf16 v[60:75], a[128:131], a[244:247], v[60:75]
  ds_write_b128 v8, v[236:239] offset:1024
  v_mul_f32 v244, v148, v52
  v_mfma_f32_32x32x16_bf16 v[76:91], a[132:135], a[220:223], v[76:91]
  buffer_load_dwordx4 a[80:83], v0, s[28:31], s61 offen offset:2048 sc1
  v_mul_f32 v245, v149, v53
  v_cvt_pk_bf16_f32 v240, v244, v245
  v_mul_f32 v246, v150, v54
  v_mul_f32 v247, v151, v55
  v_mfma_f32_32x32x16_bf16 v[76:91], a[136:139], a[224:227], v[76:91]
  v_cvt_pk_bf16_f32 v241, v246, v247
  v_mul_f32 v244, v152, v56
  v_mul_f32 v245, v153, v57
  v_cvt_pk_bf16_f32 v242, v244, v245
  v_mul_f32 v246, v154, v58
  v_mfma_f32_32x32x16_bf16 v[76:91], a[140:143], a[228:231], v[76:91]
  buffer_load_dwordx4 a[84:87], v0, s[28:31], s64 offen offset:3072 sc1
  v_mul_f32 v247, v155, v59
  v_cvt_pk_bf16_f32 v243, v246, v247
  v_mul_f32 v244, v156, v60
  v_mul_f32 v245, v157, v61
  v_mfma_f32_32x32x16_bf16 v[76:91], a[144:147], a[232:235], v[76:91]
  ds_write_b128 v9, v[240:243] offset:1024
  v_cvt_pk_bf16_f32 v236, v244, v245
  v_mfma_f32_32x32x16_bf16 v[76:91], a[148:151], a[236:239], v[76:91]
  buffer_load_dwordx4 a[88:91], v0, s[28:31], s61 offen offset:3072 sc1
  v_mul_f32 v246, v158, v62
  v_mul_f32 v247, v159, v63
  v_cvt_pk_bf16_f32 v237, v246, v247
  v_mul_f32 v244, v160, v64
  v_mfma_f32_32x32x16_bf16 v[76:91], a[152:155], a[240:243], v[76:91]
  v_mul_f32 v245, v161, v65
  v_cvt_pk_bf16_f32 v238, v244, v245
  v_mul_f32 v246, v162, v66
  v_mul_f32 v247, v163, v67
  v_cvt_pk_bf16_f32 v239, v246, v247
  v_mfma_f32_32x32x16_bf16 v[76:91], a[156:159], a[244:247], v[76:91]
  buffer_load_dwordx4 a[92:95], v0, s[28:31], s65 offen sc1
  ds_write_b128 v8, v[236:239] offset:26624
  v_mfma_f32_32x32x16_bf16 v[92:107], a[160:163], a[220:223], v[92:107]
  v_mul_f32 v244, v164, v68
  v_mul_f32 v245, v165, v69
  v_cvt_pk_bf16_f32 v240, v244, v245
  v_mul_f32 v246, v166, v70
  v_mul_f32 v247, v167, v71
  v_mfma_f32_32x32x16_bf16 v[92:107], a[164:167], a[224:227], v[92:107]
  buffer_load_dwordx4 a[96:99], v0, s[28:31], s62 offen sc1
  v_cvt_pk_bf16_f32 v241, v246, v247
  v_mul_f32 v244, v168, v72
  v_mul_f32 v245, v169, v73
  v_cvt_pk_bf16_f32 v242, v244, v245
  v_mfma_f32_32x32x16_bf16 v[92:107], a[168:171], a[228:231], v[92:107]
  v_mul_f32 v246, v170, v74
  v_mul_f32 v247, v171, v75
  v_cvt_pk_bf16_f32 v243, v246, v247
  v_mul_f32 v244, v172, v76
  v_mul_f32 v245, v173, v77
  s_waitcnt lgkmcnt(1)
  s_barrier
  v_mfma_f32_32x32x16_bf16 v[92:107], a[172:175], a[232:235], v[92:107]
  buffer_load_dwordx4 a[100:103], v0, s[28:31], s65 offen offset:1024 sc1
  ds_read_b128 a[188:191], v4 offset:0
  ds_read_b128 a[192:195], v4 offset:13312
  ds_read_b128 a[196:199], v5 offset:0
  ds_read_b128 a[200:203], v5 offset:13312
  ds_read_b128 a[204:207], v4 offset:1024
  v_mfma_f32_32x32x16_bf16 v[92:107], a[176:179], a[236:239], v[92:107]
  ds_write_b128 v9, v[240:243] offset:26624
  v_cvt_pk_bf16_f32 v236, v244, v245
  v_mfma_f32_32x32x16_bf16 v[92:107], a[180:183], a[240:243], v[92:107]
  buffer_load_dwordx4 a[104:107], v0, s[28:31], s65 offen offset:2048 sc1
  ds_read_b128 a[208:211], v4 offset:14336
  v_mul_f32 v246, v174, v78
  v_mul_f32 v247, v175, v79
  v_cvt_pk_bf16_f32 v237, v246, v247
  v_mfma_f32_32x32x16_bf16 v[92:107], a[184:187], a[244:247], v[92:107]
  v_mul_f32 v244, v176, v80
  v_mul_f32 v245, v177, v81
  v_cvt_pk_bf16_f32 v238, v244, v245
  v_mul_f32 v246, v178, v82
  v_mul_f32 v247, v179, v83
  s_waitcnt vmcnt(25) lgkmcnt(6)
  v_mfma_f32_16x16x32_bf16 v[204:207], a[0:3], a[188:191], 0
  buffer_load_dwordx4 a[108:111], v0, s[28:31], s65 offen offset:3072 sc1
  ds_read_b128 a[212:215], v5 offset:1024
  v_mfma_f32_16x16x32_bf16 v[208:211], a[4:7], a[188:191], 0
  v_cvt_pk_bf16_f32 v239, v246, v247
  v_mul_f32 v244, v180, v84
  s_waitcnt lgkmcnt(6)
  v_mfma_f32_16x16x32_bf16 v[212:215], a[0:3], a[192:195], 0
  ds_read_b128 a[216:219], v5 offset:14336
  v_mul_f32 v245, v181, v85
  v_mfma_f32_16x16x32_bf16 v[216:219], a[4:7], a[192:195], 0
  ds_write_b128 v10, v[236:239] offset:26624
  s_waitcnt vmcnt(24) lgkmcnt(7)
  v_mfma_f32_16x16x32_bf16 v[204:207], a[8:11], a[196:199], v[204:207]
  buffer_load_dwordx4 a[112:115], v0, s[28:31], s66 offen sc1
  ds_read_b128 a[188:191], v4 offset:2048
  v_mfma_f32_16x16x32_bf16 v[208:211], a[12:15], a[196:199], v[208:211]
  v_cvt_pk_bf16_f32 v240, v244, v245
  v_mul_f32 v246, v182, v86
  s_waitcnt lgkmcnt(7)
  v_mfma_f32_16x16x32_bf16 v[212:215], a[8:11], a[200:203], v[212:215]
  ds_read_b128 a[192:195], v4 offset:15360
  v_mul_f32 v247, v183, v87
  v_mfma_f32_16x16x32_bf16 v[216:219], a[12:15], a[200:203], v[216:219]
  v_cvt_pk_bf16_f32 v241, v246, v247
  v_mul_f32 v244, v184, v88
  s_waitcnt vmcnt(23) lgkmcnt(7)
  v_mfma_f32_16x16x32_bf16 v[204:207], a[16:19], a[204:207], v[204:207]
  buffer_load_dwordx4 a[116:119], v0, s[28:31], s66 offen offset:1024 sc1
  ds_read_b128 a[196:199], v5 offset:2048
  v_mfma_f32_16x16x32_bf16 v[208:211], a[20:23], a[204:207], v[208:211]
  v_mul_f32 v245, v185, v89
  v_cvt_pk_bf16_f32 v242, v244, v245
  s_waitcnt lgkmcnt(6)
  v_mfma_f32_16x16x32_bf16 v[212:215], a[16:19], a[208:211], v[212:215]
  ds_read_b128 a[200:203], v5 offset:15360
  v_mul_f32 v246, v186, v90
  v_mfma_f32_16x16x32_bf16 v[216:219], a[20:23], a[208:211], v[216:219]
  v_mul_f32 v247, v187, v91
  v_cvt_pk_bf16_f32 v243, v246, v247
  s_waitcnt vmcnt(22) lgkmcnt(6)
  v_mfma_f32_16x16x32_bf16 v[204:207], a[24:27], a[212:215], v[204:207]
  buffer_load_dwordx4 a[120:123], v0, s[28:31], s66 offen offset:2048 sc1
  ds_read_b128 a[204:207], v4 offset:3072
  v_mfma_f32_16x16x32_bf16 v[208:211], a[28:31], a[212:215], v[208:211]
  ds_write_b128 v11, v[240:243] offset:26624
  s_waitcnt lgkmcnt(7)
  v_mfma_f32_16x16x32_bf16 v[212:215], a[24:27], a[216:219], v[212:215]
  ds_read_b128 a[208:211], v4 offset:16384
  v_mul_f32 v244, v188, v92
  v_mfma_f32_16x16x32_bf16 v[216:219], a[28:31], a[216:219], v[216:219]
  v_mul_f32 v245, v189, v93
  v_cvt_pk_bf16_f32 v236, v244, v245
  s_waitcnt vmcnt(21) lgkmcnt(6)
  v_mfma_f32_16x16x32_bf16 v[204:207], a[32:35], a[188:191], v[204:207]
  buffer_load_dwordx4 a[124:127], v0, s[28:31], s66 offen offset:3072 sc1
  ds_read_b128 a[212:215], v5 offset:3072
  v_mfma_f32_16x16x32_bf16 v[208:211], a[36:39], a[188:191], v[208:211]
  v_mul_f32 v246, v190, v94
  v_mul_f32 v247, v191, v95
  s_waitcnt lgkmcnt(6)
  v_mfma_f32_16x16x32_bf16 v[212:215], a[32:35], a[192:195], v[212:215]
  ds_read_b128 a[216:219], v5 offset:16384
  v_cvt_pk_bf16_f32 v237, v246, v247
  v_mfma_f32_16x16x32_bf16 v[216:219], a[36:39], a[192:195], v[216:219]
  v_mul_f32 v244, v192, v96
  v_mul_f32 v245, v193, v97
  s_waitcnt vmcnt(20) lgkmcnt(6)
  v_mfma_f32_16x16x32_bf16 v[204:207], a[40:43], a[196:199], v[204:207]
  buffer_load_dwordx4 a[128:131], v1, s[28:31], s67 offen sc1
  ds_read_b128 a[188:191], v4 offset:4096
  v_mfma_f32_16x16x32_bf16 v[208:211], a[44:47], a[196:199], v[208:211]
  v_cvt_pk_bf16_f32 v238, v244, v245
  v_mul_f32 v246, v194, v98
  s_waitcnt lgkmcnt(6)
  v_mfma_f32_16x16x32_bf16 v[212:215], a[40:43], a[200:203], v[212:215]
  ds_read_b128 a[192:195], v4 offset:17408
  v_mul_f32 v247, v195, v99
  v_mfma_f32_16x16x32_bf16 v[216:219], a[44:47], a[200:203], v[216:219]
  v_cvt_pk_bf16_f32 v239, v246, v247
  v_mul_f32 v244, v196, v100
  s_waitcnt vmcnt(19) lgkmcnt(6)
  v_mfma_f32_16x16x32_bf16 v[204:207], a[48:51], a[204:207], v[204:207]
  buffer_load_dwordx4 a[132:135], v0, s[28:31], s67 offen offset:640 sc1
  ds_read_b128 a[196:199], v5 offset:4096
  v_mfma_f32_16x16x32_bf16 v[208:211], a[52:55], a[204:207], v[208:211]
  ds_write_b128 v8, v[236:239] offset:27648
  s_waitcnt lgkmcnt(6)
  v_mfma_f32_16x16x32_bf16 v[212:215], a[48:51], a[208:211], v[212:215]
  ds_read_b128 a[200:203], v5 offset:17408
  v_mul_f32 v245, v197, v101
  v_mfma_f32_16x16x32_bf16 v[216:219], a[52:55], a[208:211], v[216:219]
  v_cvt_pk_bf16_f32 v240, v244, v245
  v_mul_f32 v246, v198, v102
  s_waitcnt vmcnt(18) lgkmcnt(6)
  v_mfma_f32_16x16x32_bf16 v[204:207], a[56:59], a[212:215], v[204:207]
  buffer_load_dwordx4 a[136:139], v0, s[28:31], s67 offen offset:1664 sc1
  ds_read_b128 a[204:207], v4 offset:5120
  v_mfma_f32_16x16x32_bf16 v[208:211], a[60:63], a[212:215], v[208:211]
  v_mul_f32 v247, v199, v103
  v_cvt_pk_bf16_f32 v241, v246, v247
  s_waitcnt lgkmcnt(6)
  v_mfma_f32_16x16x32_bf16 v[212:215], a[56:59], a[216:219], v[212:215]
  ds_read_b128 a[208:211], v4 offset:18432
  v_mul_f32 v244, v200, v104
  v_mfma_f32_16x16x32_bf16 v[216:219], a[60:63], a[216:219], v[216:219]
  v_mul_f32 v245, v201, v105
  v_cvt_pk_bf16_f32 v242, v244, v245
  s_waitcnt vmcnt(17) lgkmcnt(6)
  v_mfma_f32_16x16x32_bf16 v[204:207], a[64:67], a[188:191], v[204:207]
  buffer_load_dwordx4 a[140:143], v0, s[28:31], s67 offen offset:2688 sc1
  ds_read_b128 a[212:215], v5 offset:5120
  v_mfma_f32_16x16x32_bf16 v[208:211], a[68:71], a[188:191], v[208:211]
  v_mul_f32 v246, v202, v106
  v_mul_f32 v247, v203, v107
  s_waitcnt lgkmcnt(6)
  v_mfma_f32_16x16x32_bf16 v[212:215], a[64:67], a[192:195], v[212:215]
  ds_read_b128 a[216:219], v5 offset:18432
  v_cvt_pk_bf16_f32 v243, v246, v247
  v_mfma_f32_16x16x32_bf16 v[216:219], a[68:71], a[192:195], v[216:219]
  ds_write_b128 v9, v[240:243] offset:27648
  s_waitcnt vmcnt(16) lgkmcnt(7)
  v_mfma_f32_16x16x32_bf16 v[204:207], a[72:75], a[196:199], v[204:207]
  buffer_load_dwordx4 a[144:147], v0, s[28:31], s67 offen offset:3712 sc1
  ds_read_b128 a[188:191], v4 offset:6144
  v_mfma_f32_16x16x32_bf16 v[208:211], a[76:79], a[196:199], v[208:211]
  s_waitcnt lgkmcnt(6)
  v_mfma_f32_16x16x32_bf16 v[212:215], a[72:75], a[200:203], v[212:215]
  ds_read_b128 a[192:195], v4 offset:19456
  v_mfma_f32_16x16x32_bf16 v[216:219], a[76:79], a[200:203], v[216:219]
  s_waitcnt vmcnt(15) lgkmcnt(2)
  v_mfma_f32_16x16x32_bf16 v[204:207], a[80:83], a[204:207], v[204:207]
  buffer_load_dwordx4 a[148:151], v0, s[28:31], s68 offen offset:640 sc1
  s_barrier
  v_mfma_f32_16x16x32_bf16 v[208:211], a[84:87], a[204:207], v[208:211]
  ds_read_b128 a[196:199], v4 offset:26624
  v_mfma_f32_16x16x32_bf16 v[212:215], a[80:83], a[208:211], v[212:215]
  ds_read_b128 a[200:203], v4 offset:39936
  v_mfma_f32_16x16x32_bf16 v[216:219], a[84:87], a[208:211], v[216:219]
  s_waitcnt vmcnt(14)
  v_mfma_f32_16x16x32_bf16 v[204:207], a[88:91], a[212:215], v[204:207]
  buffer_load_dwordx4 a[152:155], v0, s[28:31], s68 offen offset:1664 sc1
  ds_read_b128 a[204:207], v5 offset:26624
  v_mfma_f32_16x16x32_bf16 v[208:211], a[92:95], a[212:215], v[208:211]
  v_mfma_f32_16x16x32_bf16 v[212:215], a[88:91], a[216:219], v[212:215]
  ds_read_b128 a[208:211], v5 offset:39936
  v_mfma_f32_16x16x32_bf16 v[216:219], a[92:95], a[216:219], v[216:219]
  s_waitcnt vmcnt(13) lgkmcnt(5)
  v_mfma_f32_16x16x32_bf16 v[204:207], a[96:99], a[188:191], v[204:207]
  buffer_load_dwordx4 a[156:159], v1, s[28:31], s68 offen offset:2688 sc1
  ds_read_b128 a[212:215], v4 offset:27648
  v_mfma_f32_16x16x32_bf16 v[208:211], a[100:103], a[188:191], v[208:211]
  s_waitcnt lgkmcnt(5)
  v_mfma_f32_16x16x32_bf16 v[212:215], a[96:99], a[192:195], v[212:215]
  ds_read_b128 a[216:219], v4 offset:40960
  v_mfma_f32_16x16x32_bf16 v[216:219], a[100:103], a[192:195], v[216:219]
  s_waitcnt lgkmcnt(5)
  v_mfma_f32_16x16x32_bf16 v[220:223], a[0:3], a[196:199], 0
  buffer_load_dwordx4 a[160:163], v0, s[28:31], s68 offen offset:3328 sc1
  ds_read_b128 a[188:191], v5 offset:27648
  v_mfma_f32_16x16x32_bf16 v[224:227], a[4:7], a[196:199], 0
  v_cvt_pk_bf16_f32 v204, v204, v205
  v_cvt_pk_bf16_f32 v205, v206, v207
  s_waitcnt lgkmcnt(5)
  v_mfma_f32_16x16x32_bf16 v[228:231], a[0:3], a[200:203], 0
  ds_read_b128 a[192:195], v5 offset:40960
  v_cvt_pk_bf16_f32 v206, v208, v209
  v_mfma_f32_16x16x32_bf16 v[232:235], a[4:7], a[200:203], 0
  v_cvt_pk_bf16_f32 v207, v210, v211
  s_waitcnt lgkmcnt(5)
  v_mfma_f32_16x16x32_bf16 v[220:223], a[8:11], a[204:207], v[220:223]
  buffer_load_dwordx4 a[164:167], v0, s[28:31], s69 offen offset:256 sc1
  ds_read_b128 a[196:199], v4 offset:28672
  v_mfma_f32_16x16x32_bf16 v[224:227], a[12:15], a[204:207], v[224:227]
  ds_write_b128 v2, v[204:207] offset:0
  s_waitcnt lgkmcnt(6)
  v_mfma_f32_16x16x32_bf16 v[228:231], a[8:11], a[208:211], v[228:231]
  ds_read_b128 a[200:203], v4 offset:41984
  v_cvt_pk_bf16_f32 v212, v212, v213
  v_mfma_f32_16x16x32_bf16 v[232:235], a[12:15], a[208:211], v[232:235]
  v_cvt_pk_bf16_f32 v213, v214, v215
  v_cvt_pk_bf16_f32 v214, v216, v217
  s_waitcnt lgkmcnt(6)
  v_mfma_f32_16x16x32_bf16 v[220:223], a[16:19], a[212:215], v[220:223]
  buffer_load_dwordx4 a[168:171], v0, s[28:31], s69 offen offset:1280 sc1
  ds_read_b128 a[204:207], v5 offset:28672
  v_mfma_f32_16x16x32_bf16 v[224:227], a[20:23], a[212:215], v[224:227]
  v_cvt_pk_bf16_f32 v215, v218, v219
  s_waitcnt lgkmcnt(6)
  v_mfma_f32_16x16x32_bf16 v[228:231], a[16:19], a[216:219], v[228:231]
  ds_read_b128 a[208:211], v5 offset:41984
  v_mfma_f32_16x16x32_bf16 v[232:235], a[20:23], a[216:219], v[232:235]
  ds_write_b128 v2, v[212:215] offset:256
  s_waitcnt lgkmcnt(7)
  v_mfma_f32_16x16x32_bf16 v[220:223], a[24:27], a[188:191], v[220:223]
  buffer_load_dwordx4 a[172:175], v0, s[28:31], s69 offen offset:2304 sc1
  ds_read_b128 a[212:215], v4 offset:29696
  v_mfma_f32_16x16x32_bf16 v[224:227], a[28:31], a[188:191], v[224:227]
  s_waitcnt lgkmcnt(1)
  v_mfma_f32_16x16x32_bf16 v[228:231], a[24:27], a[192:195], v[228:231]
  ds_read_b128 a[216:219], v4 offset:43008
  s_barrier
  v_mfma_f32_16x16x32_bf16 v[232:235], a[28:31], a[192:195], v[232:235]
  v_mfma_f32_16x16x32_bf16 v[220:223], a[32:35], a[196:199], v[220:223]
  buffer_load_dwordx4 a[176:179], v0, s[28:31], s69 offen offset:3328 sc1
  ds_read_b128 a[188:191], v5 offset:29696
  v_mfma_f32_16x16x32_bf16 v[224:227], a[36:39], a[196:199], v[224:227]
  v_mfma_f32_16x16x32_bf16 v[228:231], a[32:35], a[200:203], v[228:231]
  ds_read_b128 a[192:195], v5 offset:43008
  v_mfma_f32_16x16x32_bf16 v[232:235], a[36:39], a[200:203], v[232:235]
  v_mfma_f32_16x16x32_bf16 v[220:223], a[40:43], a[204:207], v[220:223]
  buffer_load_dwordx4 a[180:183], v0, s[28:31], s70 offen offset:256 sc1
  ds_read_b128 a[196:199], v4 offset:30720
  v_mfma_f32_16x16x32_bf16 v[224:227], a[44:47], a[204:207], v[224:227]
  v_mfma_f32_16x16x32_bf16 v[228:231], a[40:43], a[208:211], v[228:231]
  ds_read_b128 a[200:203], v4 offset:44032
  v_mfma_f32_16x16x32_bf16 v[232:235], a[44:47], a[208:211], v[232:235]
  s_waitcnt lgkmcnt(5)
  v_mfma_f32_16x16x32_bf16 v[220:223], a[48:51], a[212:215], v[220:223]
  buffer_load_dwordx4 a[184:187], v1, s[28:31], s70 offen offset:1280 sc1
  ds_read_b128 a[204:207], v5 offset:30720
  v_mfma_f32_16x16x32_bf16 v[224:227], a[52:55], a[212:215], v[224:227]
  s_waitcnt lgkmcnt(5)
  v_mfma_f32_16x16x32_bf16 v[228:231], a[48:51], a[216:219], v[228:231]
  ds_read_b128 a[208:211], v5 offset:44032
  v_mfma_f32_16x16x32_bf16 v[232:235], a[52:55], a[216:219], v[232:235]
  s_waitcnt lgkmcnt(5)
  v_mfma_f32_16x16x32_bf16 v[220:223], a[56:59], a[188:191], v[220:223]
  s_add_u32 s28, s28, 175232
  s_addc_u32 s29, s29, 0
  s_sub_u32 s30, s30, 175232
  buffer_load_dwordx4 a[0:3], v0, s[28:31], 0 offen sc1
  ds_read_b128 a[212:215], v4 offset:31744
  v_mfma_f32_16x16x32_bf16 v[224:227], a[60:63], a[188:191], v[224:227]
  s_waitcnt lgkmcnt(5)
  v_mfma_f32_16x16x32_bf16 v[228:231], a[56:59], a[192:195], v[228:231]
  ds_read_b128 a[216:219], v4 offset:45056
  v_mfma_f32_16x16x32_bf16 v[232:235], a[60:63], a[192:195], v[232:235]
  s_waitcnt lgkmcnt(5)
  v_mfma_f32_16x16x32_bf16 v[220:223], a[64:67], a[196:199], v[220:223]
  buffer_load_dwordx4 a[4:7], v0, s[28:31], s62 offen offset:1024 sc1
  ds_read_b128 a[188:191], v5 offset:31744
  v_mfma_f32_16x16x32_bf16 v[224:227], a[68:71], a[196:199], v[224:227]
  s_waitcnt lgkmcnt(5)
  v_mfma_f32_16x16x32_bf16 v[228:231], a[64:67], a[200:203], v[228:231]
  ds_read_b128 a[192:195], v5 offset:45056
  v_mfma_f32_16x16x32_bf16 v[232:235], a[68:71], a[200:203], v[232:235]
  s_waitcnt lgkmcnt(5)
  v_mfma_f32_16x16x32_bf16 v[220:223], a[72:75], a[204:207], v[220:223]
  buffer_load_dwordx4 a[8:11], v0, s[28:31], 0 offen offset:1024 sc1
  ds_read_b128 a[196:199], v4 offset:32768
  v_mfma_f32_16x16x32_bf16 v[224:227], a[76:79], a[204:207], v[224:227]
  s_waitcnt lgkmcnt(5)
  v_mfma_f32_16x16x32_bf16 v[228:231], a[72:75], a[208:211], v[228:231]
  ds_read_b128 a[200:203], v4 offset:46080
  v_mfma_f32_16x16x32_bf16 v[232:235], a[76:79], a[208:211], v[232:235]
  s_waitcnt lgkmcnt(5)
  v_mfma_f32_16x16x32_bf16 v[220:223], a[80:83], a[212:215], v[220:223]
  buffer_load_dwordx4 a[12:15], v0, s[28:31], s62 offen offset:2048 sc1
  v_mfma_f32_16x16x32_bf16 v[224:227], a[84:87], a[212:215], v[224:227]
  s_waitcnt lgkmcnt(4)
  v_mfma_f32_16x16x32_bf16 v[228:231], a[80:83], a[216:219], v[228:231]
  v_mfma_f32_16x16x32_bf16 v[232:235], a[84:87], a[216:219], v[232:235]
  s_waitcnt lgkmcnt(3)
  v_mfma_f32_16x16x32_bf16 v[220:223], a[88:91], a[188:191], v[220:223]
  buffer_load_dwordx4 a[16:19], v0, s[28:31], 0 offen offset:2048 sc1
  v_mfma_f32_16x16x32_bf16 v[224:227], a[92:95], a[188:191], v[224:227]
  s_waitcnt lgkmcnt(2)
  v_mfma_f32_16x16x32_bf16 v[228:231], a[88:91], a[192:195], v[228:231]
  ds_read_b128 a[220:223], v0 offset:0
  v_mfma_f32_16x16x32_bf16 v[232:235], a[92:95], a[192:195], v[232:235]
  ds_read_b128 a[224:227], v0 offset:1024
  s_waitcnt lgkmcnt(3)
  v_mfma_f32_16x16x32_bf16 v[220:223], a[96:99], a[196:199], v[220:223]
  buffer_load_dwordx4 a[20:23], v0, s[28:31], s62 offen offset:3072 sc1
  ds_read_b128 a[228:231], v0 offset:2048
  v_mfma_f32_16x16x32_bf16 v[224:227], a[100:103], a[196:199], v[224:227]
  ds_read_b128 a[232:235], v0 offset:3072
  s_waitcnt lgkmcnt(4)
  v_mfma_f32_16x16x32_bf16 v[228:231], a[96:99], a[200:203], v[228:231]
  ds_read_b128 a[236:239], v0 offset:4096
  v_mfma_f32_16x16x32_bf16 v[232:235], a[100:103], a[200:203], v[232:235]
  ds_read_b128 a[240:243], v0 offset:5120
  s_add_u32 s49, s49, 1
  s_cmp_lt_u32 s49, 5
  s_cbranch_scc1 standalone__cross_network_dcn_v2__recsys_kernel_loopM
  s_waitcnt vmcnt(23) lgkmcnt(4)
  v_mfma_f32_32x32x16_bf16 v[12:27], a[104:107], a[220:223], v[12:27]
  ds_read_b128 a[244:247], v0 offset:6144
  v_mfma_f32_32x32x16_bf16 v[12:27], a[108:111], a[224:227], v[12:27]
  v_cvt_pk_bf16_f32 v220, v220, v221
  v_cvt_pk_bf16_f32 v221, v222, v223
  v_cvt_pk_bf16_f32 v222, v224, v225
  v_cvt_pk_bf16_f32 v223, v226, v227
  s_waitcnt lgkmcnt(3)
  v_mfma_f32_32x32x16_bf16 v[12:27], a[112:115], a[228:231], v[12:27]
  ds_write_b128 v2, v[220:223] offset:7168
  v_cvt_pk_bf16_f32 v228, v228, v229
  v_cvt_pk_bf16_f32 v229, v230, v231
  v_cvt_pk_bf16_f32 v230, v232, v233
  v_mfma_f32_32x32x16_bf16 v[12:27], a[116:119], a[232:235], v[12:27]
  v_cvt_pk_bf16_f32 v231, v234, v235
  ds_write_b128 v2, v[228:231] offset:7424
  s_waitcnt vmcnt(19) lgkmcnt(3)
  v_mfma_f32_32x32x16_bf16 v[12:27], a[120:123], a[236:239], v[12:27]
  v_mfma_f32_32x32x16_bf16 v[12:27], a[124:127], a[240:243], v[12:27]
  s_waitcnt lgkmcnt(2)
  v_mfma_f32_32x32x16_bf16 v[12:27], a[128:131], a[244:247], v[12:27]
  v_mfma_f32_32x32x16_bf16 v[28:43], a[132:135], a[220:223], v[28:43]
  s_waitcnt vmcnt(15)
  v_mfma_f32_32x32x16_bf16 v[28:43], a[136:139], a[224:227], v[28:43]
  s_nop 8
  v_mul_f32 v244, v108, v12
  v_mul_f32 v245, v109, v13
  v_cvt_pk_bf16_f32 v236, v244, v245
  v_mul_f32 v246, v110, v14
  v_mul_f32 v247, v111, v15
  v_mfma_f32_32x32x16_bf16 v[28:43], a[140:143], a[228:231], v[28:43]
  v_cvt_pk_bf16_f32 v237, v246, v247
  v_mul_f32 v244, v112, v16
  v_mul_f32 v245, v113, v17
  v_cvt_pk_bf16_f32 v238, v244, v245
  v_mul_f32 v246, v114, v18
  s_waitcnt lgkmcnt(0)
  s_barrier
  v_mfma_f32_32x32x16_bf16 v[28:43], a[144:147], a[232:235], v[28:43]
  v_mul_f32 v247, v115, v19
  v_cvt_pk_bf16_f32 v239, v246, v247
  v_mul_f32 v244, v116, v20
  v_mul_f32 v245, v117, v21
  v_cvt_pk_bf16_f32 v240, v244, v245
  v_mfma_f32_32x32x16_bf16 v[28:43], a[148:151], a[236:239], v[28:43]
  ds_write_b128 v8, v[236:239] offset:0
  v_mul_f32 v246, v118, v22
  s_waitcnt vmcnt(11)
  v_mfma_f32_32x32x16_bf16 v[28:43], a[152:155], a[240:243], v[28:43]
  v_mul_f32 v247, v119, v23
  v_cvt_pk_bf16_f32 v241, v246, v247
  v_mul_f32 v244, v120, v24
  v_mul_f32 v245, v121, v25
  v_cvt_pk_bf16_f32 v242, v244, v245
  v_mfma_f32_32x32x16_bf16 v[28:43], a[156:159], a[244:247], v[28:43]
  v_mul_f32 v246, v122, v26
  v_mul_f32 v247, v123, v27
  v_cvt_pk_bf16_f32 v243, v246, v247
  v_mfma_f32_32x32x16_bf16 v[44:59], a[160:163], a[220:223], v[44:59]
  ds_read_b128 a[220:223], v0 offset:7168
  ds_write_b128 v9, v[240:243] offset:0
  v_mfma_f32_32x32x16_bf16 v[44:59], a[164:167], a[224:227], v[44:59]
  ds_read_b128 a[224:227], v0 offset:8192
  s_nop 3
  v_mul_f32 v244, v124, v28
  v_mul_f32 v245, v125, v29
  v_cvt_pk_bf16_f32 v236, v244, v245
  v_mul_f32 v246, v126, v30
  s_waitcnt vmcnt(7)
  v_mfma_f32_32x32x16_bf16 v[44:59], a[168:171], a[228:231], v[44:59]
  ds_read_b128 a[228:231], v0 offset:9216
  v_mul_f32 v247, v127, v31
  v_cvt_pk_bf16_f32 v237, v246, v247
  v_mul_f32 v244, v128, v32
  v_mul_f32 v245, v129, v33
  v_mfma_f32_32x32x16_bf16 v[44:59], a[172:175], a[232:235], v[44:59]
  ds_read_b128 a[232:235], v0 offset:10240
  v_cvt_pk_bf16_f32 v238, v244, v245
  v_mul_f32 v246, v130, v34
  v_mul_f32 v247, v131, v35
  v_cvt_pk_bf16_f32 v239, v246, v247
  v_mfma_f32_32x32x16_bf16 v[44:59], a[176:179], a[236:239], v[44:59]
  ds_read_b128 a[236:239], v0 offset:11264
  ds_write_b128 v10, v[236:239] offset:0
  v_mfma_f32_32x32x16_bf16 v[44:59], a[180:183], a[240:243], v[44:59]
  ds_read_b128 a[240:243], v0 offset:12288
  v_mul_f32 v244, v132, v36
  v_mul_f32 v245, v133, v37
  v_cvt_pk_bf16_f32 v240, v244, v245
  v_mul_f32 v246, v134, v38
  s_waitcnt vmcnt(6)
  v_mfma_f32_32x32x16_bf16 v[44:59], a[184:187], a[244:247], v[44:59]
  ds_read_b128 a[244:247], v0 offset:13312
  v_mul_f32 v247, v135, v39
  v_cvt_pk_bf16_f32 v241, v246, v247
  v_mul_f32 v244, v136, v40
  v_mul_f32 v245, v137, v41
  s_waitcnt lgkmcnt(6)
  v_mfma_f32_32x32x16_bf16 v[60:75], a[104:107], a[220:223], v[60:75]
  v_cvt_pk_bf16_f32 v242, v244, v245
  v_mul_f32 v246, v138, v42
  v_mul_f32 v247, v139, v43
  v_cvt_pk_bf16_f32 v243, v246, v247
  v_mfma_f32_32x32x16_bf16 v[60:75], a[108:111], a[224:227], v[60:75]
  ds_write_b128 v11, v[240:243] offset:0
  v_mul_f32 v244, v140, v44
  s_waitcnt lgkmcnt(5)
  v_mfma_f32_32x32x16_bf16 v[60:75], a[112:115], a[228:231], v[60:75]
  v_mul_f32 v245, v141, v45
  v_cvt_pk_bf16_f32 v236, v244, v245
  v_mul_f32 v246, v142, v46
  v_mul_f32 v247, v143, v47
  v_cvt_pk_bf16_f32 v237, v246, v247
  v_mfma_f32_32x32x16_bf16 v[60:75], a[116:119], a[232:235], v[60:75]
  v_mul_f32 v244, v144, v48
  v_mul_f32 v245, v145, v49
  v_cvt_pk_bf16_f32 v238, v244, v245
  v_mul_f32 v246, v146, v50
  v_mul_f32 v247, v147, v51
  s_waitcnt lgkmcnt(2)
  v_mfma_f32_32x32x16_bf16 v[60:75], a[120:123], a[236:239], v[60:75]
  v_cvt_pk_bf16_f32 v239, v246, v247
  ds_write_b128 v8, v[236:239] offset:1024
  v_mfma_f32_32x32x16_bf16 v[60:75], a[124:127], a[240:243], v[60:75]
  v_mul_f32 v244, v148, v52
  v_mul_f32 v245, v149, v53
  v_cvt_pk_bf16_f32 v240, v244, v245
  v_mul_f32 v246, v150, v54
  v_mul_f32 v247, v151, v55
  s_waitcnt lgkmcnt(2)
  v_mfma_f32_32x32x16_bf16 v[60:75], a[128:131], a[244:247], v[60:75]
  v_cvt_pk_bf16_f32 v241, v246, v247
  v_mul_f32 v244, v152, v56
  v_mul_f32 v245, v153, v57
  v_cvt_pk_bf16_f32 v242, v244, v245
  v_mul_f32 v246, v154, v58
  v_mfma_f32_32x32x16_bf16 v[76:91], a[132:135], a[220:223], v[76:91]
  v_mul_f32 v247, v155, v59
  v_cvt_pk_bf16_f32 v243, v246, v247
  v_mfma_f32_32x32x16_bf16 v[76:91], a[136:139], a[224:227], v[76:91]
  ds_write_b128 v9, v[240:243] offset:1024
  s_nop 1
  v_mul_f32 v244, v156, v60
  s_waitcnt lgkmcnt(0)
  s_barrier
  v_mfma_f32_32x32x16_bf16 v[76:91], a[140:143], a[228:231], v[76:91]
  v_mul_f32 v245, v157, v61
  v_cvt_pk_bf16_f32 v236, v244, v245
  v_mul_f32 v246, v158, v62
  v_mul_f32 v247, v159, v63
  v_cvt_pk_bf16_f32 v237, v246, v247
  ds_read_b128 a[188:191], v248 offset:0
  ds_read_b128 a[192:195], v248 offset:1024
  v_mfma_f32_32x32x16_bf16 v[76:91], a[144:147], a[232:235], v[76:91]
  v_mul_f32 v244, v160, v64
  v_mul_f32 v245, v161, v65
  v_cvt_pk_bf16_f32 v238, v244, v245
  v_mul_f32 v246, v162, v66
  v_mul_f32 v247, v163, v67
  ds_read_b128 a[196:199], v248 offset:2048
  ds_read_b128 a[200:203], v248 offset:13312
  v_mfma_f32_32x32x16_bf16 v[76:91], a[148:151], a[236:239], v[76:91]
  v_cvt_pk_bf16_f32 v239, v246, v247
  ds_write_b128 v8, v[236:239] offset:26624
  ds_read_b128 a[204:207], v248 offset:14336
  ds_read_b128 a[208:211], v248 offset:15360
  v_mfma_f32_32x32x16_bf16 v[76:91], a[152:155], a[240:243], v[76:91]
  v_mul_f32 v244, v164, v68
  v_mul_f32 v245, v165, v69
  v_cvt_pk_bf16_f32 v240, v244, v245
  v_mul_f32 v246, v166, v70
  v_mul_f32 v247, v167, v71
  s_waitcnt lgkmcnt(4)
  buffer_store_dwordx4 a[188:191], v3, s[24:27], s56 offen nt
  v_mfma_f32_32x32x16_bf16 v[76:91], a[156:159], a[244:247], v[76:91]
  v_cvt_pk_bf16_f32 v241, v246, v247
  v_mul_f32 v244, v168, v72
  v_mul_f32 v245, v169, v73
  v_cvt_pk_bf16_f32 v242, v244, v245
  v_mul_f32 v246, v170, v74
  buffer_store_dwordx4 a[192:195], v3, s[24:27], s56 offen offset:128 nt
  v_mfma_f32_32x32x16_bf16 v[92:107], a[160:163], a[220:223], v[92:107]
  v_mul_f32 v247, v171, v75
  v_cvt_pk_bf16_f32 v243, v246, v247
  buffer_store_dwordx4 a[196:199], v3, s[24:27], s56 offen offset:256 nt
  v_mfma_f32_32x32x16_bf16 v[92:107], a[164:167], a[224:227], v[92:107]
  ds_write_b128 v9, v[240:243] offset:26624
  v_mul_f32 v244, v172, v76
  s_waitcnt lgkmcnt(1)
  buffer_store_dwordx4 a[200:203], v3, s[24:27], s57 offen nt
  v_mfma_f32_32x32x16_bf16 v[92:107], a[168:171], a[228:231], v[92:107]
  v_mul_f32 v245, v173, v77
  v_cvt_pk_bf16_f32 v236, v244, v245
  v_mul_f32 v246, v174, v78
  v_mul_f32 v247, v175, v79
  v_cvt_pk_bf16_f32 v237, v246, v247
  buffer_store_dwordx4 a[204:207], v3, s[24:27], s57 offen offset:128 nt
  v_mfma_f32_32x32x16_bf16 v[92:107], a[172:175], a[232:235], v[92:107]
  v_mul_f32 v244, v176, v80
  v_mul_f32 v245, v177, v81
  v_cvt_pk_bf16_f32 v238, v244, v245
  v_mul_f32 v246, v178, v82
  v_mul_f32 v247, v179, v83
  buffer_store_dwordx4 a[208:211], v3, s[24:27], s57 offen offset:256 nt
  v_mfma_f32_32x32x16_bf16 v[92:107], a[176:179], a[236:239], v[92:107]
  v_cvt_pk_bf16_f32 v239, v246, v247
  ds_write_b128 v10, v[236:239] offset:26624
  v_mfma_f32_32x32x16_bf16 v[92:107], a[180:183], a[240:243], v[92:107]
  v_mul_f32 v244, v180, v84
  v_mul_f32 v245, v181, v85
  v_cvt_pk_bf16_f32 v240, v244, v245
  v_mul_f32 v246, v182, v86
  v_mul_f32 v247, v183, v87
  v_mfma_f32_32x32x16_bf16 v[92:107], a[184:187], a[244:247], v[92:107]
  v_cvt_pk_bf16_f32 v241, v246, v247
  v_mul_f32 v244, v184, v88
  v_mul_f32 v245, v185, v89
  v_cvt_pk_bf16_f32 v242, v244, v245
  v_mul_f32 v246, v186, v90
  v_mul_f32 v247, v187, v91
  v_cvt_pk_bf16_f32 v243, v246, v247
  ds_write_b128 v11, v[240:243] offset:26624
  s_nop 3
  v_mul_f32 v244, v188, v92
  v_mul_f32 v245, v189, v93
  v_cvt_pk_bf16_f32 v236, v244, v245
  v_mul_f32 v246, v190, v94
  v_mul_f32 v247, v191, v95
  v_cvt_pk_bf16_f32 v237, v246, v247
  v_mul_f32 v244, v192, v96
  v_mul_f32 v245, v193, v97
  v_cvt_pk_bf16_f32 v238, v244, v245
  v_mul_f32 v246, v194, v98
  v_mul_f32 v247, v195, v99
  v_cvt_pk_bf16_f32 v239, v246, v247
  ds_write_b128 v8, v[236:239] offset:27648
  v_mul_f32 v244, v196, v100
  v_mul_f32 v245, v197, v101
  v_cvt_pk_bf16_f32 v240, v244, v245
  v_mul_f32 v246, v198, v102
  v_mul_f32 v247, v199, v103
  v_cvt_pk_bf16_f32 v241, v246, v247
  v_mul_f32 v244, v200, v104
  v_mul_f32 v245, v201, v105
  v_cvt_pk_bf16_f32 v242, v244, v245
  v_mul_f32 v246, v202, v106
  v_mul_f32 v247, v203, v107
  v_cvt_pk_bf16_f32 v243, v246, v247
  ds_write_b128 v9, v[240:243] offset:27648
  s_waitcnt lgkmcnt(0)
  s_barrier
  s_waitcnt vmcnt(6)
  ds_read_b128 a[0:3], v248 offset:26624
  ds_read_b128 a[4:7], v248 offset:27648
  ds_read_b128 a[8:11], v248 offset:28672
  ds_read_b128 a[12:15], v248 offset:39936
  ds_read_b128 a[16:19], v248 offset:40960
  ds_read_b128 a[20:23], v248 offset:41984
  s_waitcnt lgkmcnt(0)
  buffer_store_dwordx4 a[0:3], v3, s[24:27], s58 offen nt
  buffer_store_dwordx4 a[4:7], v3, s[24:27], s58 offen offset:128 nt
  buffer_store_dwordx4 a[8:11], v3, s[24:27], s58 offen offset:256 nt
  buffer_store_dwordx4 a[12:15], v3, s[24:27], s59 offen nt
  buffer_store_dwordx4 a[16:19], v3, s[24:27], s59 offen offset:128 nt
  buffer_store_dwordx4 a[20:23], v3, s[24:27], s59 offen offset:256 nt
standalone__cross_network_dcn_v2__recsys_kernel_done:
  s_endpgm
standalone__cross_network_dcn_v2__recsys_kernel_Rp0:
  v_lshlrev_b32 v0, 4, v252
  v_lshrrev_b32 v8, 4, v252
  v_and_b32 v9, 3, v252
  v_xor_b32 v9, v9, v8
  v_lshlrev_b32 v3, 4, v9
  v_lshrrev_b32 v9, 3, v252
  v_and_b32 v9, 1, v9
  v_lshlrev_b32 v9, 2, v9
  v_or_b32 v8, v8, v9
  v_mul_u32_u24 v8, 1664, v8
  v_and_b32 v9, 4, v252
  v_lshlrev_b32 v9, 4, v9
  v_add3_u32 v3, v3, v8, v9
  s_mul_i32 s50, s3, 5042
  s_lshr_b32 s50, s50, 16
  s_mul_i32 s51, s50, 13
  s_sub_u32 s72, s3, s51
  s_add_u32 s50, s50, 1
  s_mul_i32 s73, s50, 86528
  s_mul_i32 s74, s50, 175232
  s_cmp_gt_u32 s72, 6
  s_cbranch_scc1 standalone__cross_network_dcn_v2__recsys_kernel_Rp0u
  s_cmp_eq_u32 s72, 6
  s_cbranch_scc1 standalone__cross_network_dcn_v2__recsys_kernel_Rp0l
  s_lshr_b32 s51, s72, 1
  s_and_b32 s52, s72, 1
  s_mul_i32 s53, s51, 26624
  s_add_u32 s73, s73, s53
  s_mul_i32 s53, s52, 3328
  s_add_u32 s73, s73, s53
  s_mul_i32 s53, s51, 46976
  s_add_u32 s74, s74, s53
  s_mul_i32 s53, s52, 13312
  s_add_u32 s74, s74, s53
  v_lshrrev_b32 v40, 2, v252
  v_and_b32 v41, 12, v40
  v_add_u32 v40, v40, v41
  v_mul_u32_u24 v40, 832, v40
  v_lshrrev_b32 v41, 5, v252
  v_lshlrev_b32 v41, 1, v41
  v_and_b32 v42, 3, v252
  v_xor_b32 v41, v41, v42
  v_lshlrev_b32 v41, 4, v41
  v_add_u32 v44, v40, v41
  v_and_b32 v40, 15, v252
  v_lshrrev_b32 v41, 3, v40
  v_lshlrev_b32 v41, 1, v41
  v_lshrrev_b32 v42, 4, v252
  v_xor_b32 v41, v41, v42
  v_lshlrev_b32 v41, 4, v41
  v_lshlrev_b32 v40, 6, v40
  v_add_u32 v224, v40, v41
  s_waitcnt lgkmcnt(0)
  s_mov_b32 s20, s4
  s_mov_b32 s21, s5
  s_mov_b32 s22, 13631488
  s_mov_b32 s23, 0x20000
  s_mov_b32 s32, s8
  s_mov_b32 s33, s9
  s_mov_b32 s34, 519168
  s_mov_b32 s35, 0x20000
  s_mov_b32 m0, 0
  s_nop 0
  buffer_load_dwordx4 v44, s[32:35], s73 offen offset:0 lds
  s_mov_b32 m0, 960
  s_nop 0
  buffer_load_dwordx4 v44, s[32:35], s73 offen offset:64 lds
  s_mov_b32 m0, 1920
  s_nop 0
  buffer_load_dwordx4 v44, s[32:35], s73 offen offset:128 lds
  s_mov_b32 m0, 2880
  s_nop 0
  buffer_load_dwordx4 v44, s[32:35], s73 offen offset:192 lds
  s_mov_b32 m0, 3840
  s_nop 0
  buffer_load_dwordx4 v44, s[32:35], s73 offen offset:256 lds
  s_mov_b32 m0, 4800
  s_nop 0
  buffer_load_dwordx4 v44, s[32:35], s73 offen offset:320 lds
  s_mov_b32 m0, 5760
  s_nop 0
  buffer_load_dwordx4 v44, s[32:35], s73 offen offset:384 lds
  s_mov_b32 m0, 6720
  s_nop 0
  buffer_load_dwordx4 v44, s[32:35], s73 offen offset:448 lds
  s_mov_b32 m0, 7680
  s_nop 0
  buffer_load_dwordx4 v44, s[32:35], s73 offen offset:512 lds
  s_mov_b32 m0, 8640
  s_nop 0
  buffer_load_dwordx4 v44, s[32:35], s73 offen offset:576 lds
  s_mov_b32 m0, 9600
  s_nop 0
  buffer_load_dwordx4 v44, s[32:35], s73 offen offset:640 lds
  s_mov_b32 m0, 10560
  s_nop 0
  buffer_load_dwordx4 v44, s[32:35], s73 offen offset:704 lds
  s_mov_b32 m0, 11520
  s_nop 0
  buffer_load_dwordx4 v44, s[32:35], s73 offen offset:768 lds
  s_cmp_lt_u32 s3, 13
  s_cbranch_scc1 standalone__cross_network_dcn_v2__recsys_kernel_Rnp0
  s_branch standalone__cross_network_dcn_v2__recsys_kernel_Rnp0b
standalone__cross_network_dcn_v2__recsys_kernel_Rp0u:
  s_lshl_b32 s71, s72, 1
  s_sub_u32 s71, s71, 13
  s_mul_i32 s53, s71, 6656
  s_add_u32 s73, s73, s53
  s_mul_i32 s53, s50, 832
  s_lshl_b32 s51, s71, 6
  s_add_u32 s75, s53, s51
  s_mov_b32 s54, s74
  s_mul_i32 s51, s71, 86
  s_lshr_b32 s51, s51, 8
  s_min_u32 s51, s51, 3
  s_mul_i32 s52, s51, 26624
  s_add_u32 s74, s74, s52
  s_mul_i32 s52, s71, 6784
  s_add_u32 s74, s74, s52
  s_mov_b32 s52, 26624
  s_cmp_eq_u32 s51, 3
  s_cselect_b32 s52, 7168, s52
  s_add_u32 s74, s74, s52
  s_add_u32 s71, s71, 1
  s_mul_i32 s51, s71, 86
  s_lshr_b32 s51, s51, 8
  s_min_u32 s51, s51, 3
  s_mul_i32 s52, s51, 26624
  s_add_u32 s54, s54, s52
  s_mul_i32 s52, s71, 6784
  s_add_u32 s54, s54, s52
  s_mov_b32 s52, 26624
  s_cmp_eq_u32 s51, 3
  s_cselect_b32 s52, 7168, s52
  s_add_u32 s54, s54, s52
  v_and_b32 v40, 31, v252
  v_and_b32 v42, 0x13, v40
  v_and_b32 v43, 4, v40
  v_lshlrev_b32 v43, 1, v43
  v_or_b32 v42, v42, v43
  v_and_b32 v43, 8, v40
  v_lshrrev_b32 v43, 1, v43
  v_or_b32 v42, v42, v43
  v_lshrrev_b32 v41, 5, v252
  v_lshlrev_b32 v41, 4, v41
  v_mul_u32_u24 v43, 208, v42
  v_add3_u32 v224, v43, v41, 0
  v_lshlrev_b32 v42, 1, v42
  s_waitcnt lgkmcnt(0)
  s_mov_b32 s20, s4
  s_mov_b32 s21, s5
  s_mov_b32 s22, 13631488
  s_mov_b32 s23, 0x20000
  s_mov_b32 s32, s8
  s_mov_b32 s33, s9
  s_mov_b32 s34, 519168
  s_mov_b32 s35, 0x20000
  s_mov_b32 s36, s6
  s_mov_b32 s37, s7
  s_mov_b32 s38, 519168
  s_mov_b32 s39, 0x20000
  s_mov_b32 s40, s10
  s_mov_b32 s41, s11
  s_mov_b32 s42, 4992
  s_mov_b32 s43, 0x20000
  s_mov_b32 m0, 0
  s_nop 0
  buffer_load_dwordx4 v0, s[36:39], s73 offen offset:0 lds
  buffer_load_dwordx4 v0, s[36:39], s73 offen offset:1024 lds
  buffer_load_dwordx4 v0, s[36:39], s73 offen offset:2048 lds
  buffer_load_dwordx4 v0, s[36:39], s73 offen offset:3072 lds
  s_mov_b32 m0, 4096
  s_add_u32 s73, s73, 4096
  buffer_load_dwordx4 v0, s[36:39], s73 offen offset:0 lds
  buffer_load_dwordx4 v0, s[36:39], s73 offen offset:1024 lds
  buffer_load_dwordx4 v0, s[36:39], s73 offen offset:2048 lds
  buffer_load_dwordx4 v0, s[36:39], s73 offen offset:3072 lds
  s_mov_b32 m0, 8192
  s_add_u32 s73, s73, 4096
  buffer_load_dwordx4 v0, s[36:39], s73 offen offset:0 lds
  buffer_load_dwordx4 v0, s[36:39], s73 offen offset:1024 lds
  buffer_load_dwordx4 v0, s[36:39], s73 offen offset:2048 lds
  buffer_load_dwordx4 v0, s[36:39], s73 offen offset:3072 lds
  s_mov_b32 m0, 12288
  s_add_u32 s73, s73, 4096
  buffer_load_dwordx4 v0, s[36:39], s73 offen offset:0 lds
  buffer_load_ushort v225, v42, s[40:43], s75 offen
  buffer_load_ushort v227, v42, s[40:43], s75 offen offset:64
  s_cmp_lt_u32 s3, 13
  s_cbranch_scc1 standalone__cross_network_dcn_v2__recsys_kernel_Rnp0
  s_branch standalone__cross_network_dcn_v2__recsys_kernel_Rnp0b
standalone__cross_network_dcn_v2__recsys_kernel_Rp0l:
  s_mul_i32 s75, s50, 832
  s_add_u32 s54, s74, 26624
  s_add_u32 s74, s74, 140928
  s_add_u32 s71, s73, 79872
  v_and_b32 v40, 15, v252
  v_lshrrev_b32 v41, 2, v40
  v_lshlrev_b32 v41, 1, v41
  v_and_b32 v42, 1, v40
  v_add_u32 v41, v41, v42
  v_mul_u32_u24 v41, 832, v41
  v_and_b32 v42, 2, v40
  v_lshlrev_b32 v42, 5, v42
  v_lshrrev_b32 v43, 4, v252
  v_lshlrev_b32 v43, 4, v43
  v_add3_u32 v224, v41, v42, v43
  v_and_b32 v40, 31, v252
  v_and_b32 v42, 0x13, v40
  v_and_b32 v43, 4, v40
  v_lshlrev_b32 v43, 1, v43
  v_or_b32 v42, v42, v43
  v_and_b32 v43, 8, v40
  v_lshrrev_b32 v43, 1, v43
  v_or_b32 v42, v42, v43
  v_lshrrev_b32 v41, 5, v252
  v_lshlrev_b32 v41, 4, v41
  v_mul_u32_u24 v43, 208, v42
  v_add_u32 v43, 7168, v43
  v_add_u32 v226, v43, v41
  v_lshlrev_b32 v42, 1, v42
  s_waitcnt lgkmcnt(0)
  s_mov_b32 s20, s4
  s_mov_b32 s21, s5
  s_mov_b32 s22, 13631488
  s_mov_b32 s23, 0x20000
  s_mov_b32 s32, s8
  s_mov_b32 s33, s9
  s_mov_b32 s34, 519168
  s_mov_b32 s35, 0x20000
  s_mov_b32 s36, s6
  s_mov_b32 s37, s7
  s_mov_b32 s38, 519168
  s_mov_b32 s39, 0x20000
  s_mov_b32 s40, s10
  s_mov_b32 s41, s11
  s_mov_b32 s42, 4992
  s_mov_b32 s43, 0x20000
  s_mov_b32 m0, 0
  s_nop 0
  buffer_load_dwordx4 v0, s[32:35], s71 offen offset:0 lds
  buffer_load_dwordx4 v0, s[32:35], s71 offen offset:1024 lds
  buffer_load_dwordx4 v0, s[32:35], s71 offen offset:2048 lds
  buffer_load_dwordx4 v0, s[32:35], s71 offen offset:3072 lds
  s_mov_b32 m0, 4096
  s_add_u32 s71, s71, 4096
  buffer_load_dwordx4 v0, s[32:35], s71 offen offset:0 lds
  buffer_load_dwordx4 v0, s[32:35], s71 offen offset:1024 lds
  buffer_load_dwordx4 v0, s[32:35], s71 offen offset:2048 lds
  s_mov_b32 m0, 7168
  s_nop 0
  buffer_load_dwordx4 v0, s[36:39], s73 offen offset:0 lds
  buffer_load_dwordx4 v0, s[36:39], s73 offen offset:1024 lds
  buffer_load_dwordx4 v0, s[36:39], s73 offen offset:2048 lds
  buffer_load_dwordx4 v0, s[36:39], s73 offen offset:3072 lds
  s_mov_b32 m0, 11264
  s_add_u32 s73, s73, 4096
  buffer_load_dwordx4 v0, s[36:39], s73 offen offset:0 lds
  buffer_load_dwordx4 v0, s[36:39], s73 offen offset:1024 lds
  buffer_load_dwordx4 v0, s[36:39], s73 offen offset:2048 lds
  buffer_load_ushort v227, v42, s[40:43], s75 offen
  s_cmp_lt_u32 s3, 13
  s_cbranch_scc1 standalone__cross_network_dcn_v2__recsys_kernel_Rnp0
  s_branch standalone__cross_network_dcn_v2__recsys_kernel_Rnp0b
standalone__cross_network_dcn_v2__recsys_kernel_Rp1s:
  s_cmp_gt_u32 s72, 6
  s_cbranch_scc1 standalone__cross_network_dcn_v2__recsys_kernel_Rp1u
  s_cmp_eq_u32 s72, 6
  s_cbranch_scc1 standalone__cross_network_dcn_v2__recsys_kernel_Rp1l
  ds_read_b128 a[188:191], v224 offset:0
  ds_read_b128 a[192:195], v224 offset:1024
  ds_read_b128 a[196:199], v224 offset:2048
  ds_read_b128 a[200:203], v224 offset:3072
  ds_read_b128 a[204:207], v224 offset:4096
  ds_read_b128 a[208:211], v224 offset:5120
  ds_read_b128 a[212:215], v224 offset:6144
  ds_read_b128 a[216:219], v224 offset:7168
  ds_read_b128 a[220:223], v224 offset:8192
  ds_read_b128 a[224:227], v224 offset:9216
  ds_read_b128 a[228:231], v224 offset:10240
  ds_read_b128 a[232:235], v224 offset:11264
  ds_read_b128 a[236:239], v224 offset:12288
  s_add_u32 s50, s74, 4096
  s_add_u32 s51, s74, 8192
  s_add_u32 s52, s74, 12288
  s_waitcnt lgkmcnt(0)
  buffer_store_dwordx4 a[188:191], v0, s[28:31], s74 offen offset:0 sc1
  buffer_store_dwordx4 a[192:195], v0, s[28:31], s74 offen offset:1024 sc1
  buffer_store_dwordx4 a[196:199], v0, s[28:31], s74 offen offset:2048 sc1
  buffer_store_dwordx4 a[200:203], v0, s[28:31], s74 offen offset:3072 sc1
  buffer_store_dwordx4 a[204:207], v0, s[28:31], s50 offen offset:0 sc1
  buffer_store_dwordx4 a[208:211], v0, s[28:31], s50 offen offset:1024 sc1
  buffer_store_dwordx4 a[212:215], v0, s[28:31], s50 offen offset:2048 sc1
  buffer_store_dwordx4 a[216:219], v0, s[28:31], s50 offen offset:3072 sc1
  buffer_store_dwordx4 a[220:223], v0, s[28:31], s51 offen offset:0 sc1
  buffer_store_dwordx4 a[224:227], v0, s[28:31], s51 offen offset:1024 sc1
  buffer_store_dwordx4 a[228:231], v0, s[28:31], s51 offen offset:2048 sc1
  buffer_store_dwordx4 a[232:235], v0, s[28:31], s51 offen offset:3072 sc1
  buffer_store_dwordx4 a[236:239], v0, s[28:31], s52 offen offset:0 sc1
  s_cmp_lt_u32 s3, 13
  s_cbranch_scc0 standalone__cross_network_dcn_v2__recsys_kernel_Rnp1s
  s_barrier
  s_waitcnt vmcnt(13)
  s_branch standalone__cross_network_dcn_v2__recsys_kernel_RA3
standalone__cross_network_dcn_v2__recsys_kernel_Rp1u:
  ds_read_b128 a[188:191], v224 offset:0
  ds_read_b128 a[192:195], v224 offset:32
  ds_read_b128 a[196:199], v224 offset:64
  ds_read_b128 a[200:203], v224 offset:96
  ds_read_b128 a[204:207], v224 offset:128
  ds_read_b128 a[208:211], v224 offset:160
  ds_read_b128 a[212:215], v224 offset:192
  ds_read_b128 a[216:219], v224 offset:6656
  ds_read_b128 a[220:223], v224 offset:6688
  ds_read_b128 a[224:227], v224 offset:6720
  ds_read_b128 a[228:231], v224 offset:6752
  ds_read_b128 a[232:235], v224 offset:6784
  ds_read_b128 a[236:239], v224 offset:6816
  ds_read_b128 a[240:243], v224 offset:6848
  v_mov_b32 v239, 1073741824
  v_cmp_gt_u32 vcc, 512, v0
  v_add_u32 v240, 128, v0
  v_lshrrev_b32 v238, 2, v0
  v_cndmask_b32 v240, v239, v240, vcc
  v_cndmask_b32 v238, v239, v238, vcc
  s_waitcnt lgkmcnt(0)
  s_add_u32 s50, s74, 4096
  buffer_store_dwordx4 a[188:191], v0, s[28:31], s74 offen offset:0 sc1
  buffer_store_dwordx4 a[192:195], v0, s[28:31], s74 offen offset:1024 sc1
  buffer_store_dwordx4 a[196:199], v0, s[28:31], s74 offen offset:2048 sc1
  buffer_store_dwordx4 a[200:203], v0, s[28:31], s74 offen offset:3072 sc1
  buffer_store_dwordx4 a[204:207], v0, s[28:31], s50 offen offset:0 sc1
  buffer_store_dwordx4 a[208:211], v0, s[28:31], s50 offen offset:1024 sc1
  buffer_store_dwordx4 a[212:215], v240, s[28:31], s50 offen offset:2048 sc1
  buffer_store_dword v225, v238, s[28:31], s50 offen offset:2048 sc1
  s_add_u32 s50, s54, 4096
  buffer_store_dwordx4 a[216:219], v0, s[28:31], s54 offen offset:0 sc1
  buffer_store_dwordx4 a[220:223], v0, s[28:31], s54 offen offset:1024 sc1
  buffer_store_dwordx4 a[224:227], v0, s[28:31], s54 offen offset:2048 sc1
  buffer_store_dwordx4 a[228:231], v0, s[28:31], s54 offen offset:3072 sc1
  buffer_store_dwordx4 a[232:235], v0, s[28:31], s50 offen offset:0 sc1
  buffer_store_dwordx4 a[236:239], v0, s[28:31], s50 offen offset:1024 sc1
  buffer_store_dwordx4 a[240:243], v240, s[28:31], s50 offen offset:2048 sc1
  buffer_store_dword v227, v238, s[28:31], s50 offen offset:2048 sc1
  s_cmp_lt_u32 s3, 13
  s_cbranch_scc0 standalone__cross_network_dcn_v2__recsys_kernel_Rnp1s
  s_barrier
  s_waitcnt vmcnt(16)
  s_branch standalone__cross_network_dcn_v2__recsys_kernel_RA3
standalone__cross_network_dcn_v2__recsys_kernel_Rp1l:
  ds_read_b128 a[188:191], v224 offset:0
  ds_read_b128 a[192:195], v224 offset:128
  ds_read_b128 a[196:199], v224 offset:256
  ds_read_b128 a[200:203], v224 offset:384
  ds_read_b128 a[204:207], v224 offset:512
  ds_read_b128 a[208:211], v224 offset:640
  ds_read_b128 a[212:215], v224 offset:768
  ds_read_b128 a[216:219], v226 offset:0
  ds_read_b128 a[220:223], v226 offset:32
  ds_read_b128 a[224:227], v226 offset:64
  ds_read_b128 a[228:231], v226 offset:96
  ds_read_b128 a[232:235], v226 offset:128
  ds_read_b128 a[236:239], v226 offset:160
  ds_read_b128 a[240:243], v226 offset:192
  v_mov_b32 v239, 1073741824
  v_cmp_gt_u32 vcc, 512, v0
  v_add_u32 v240, 128, v0
  v_lshrrev_b32 v238, 2, v0
  v_cndmask_b32 v240, v239, v240, vcc
  v_cndmask_b32 v238, v239, v238, vcc
  s_add_u32 s50, s74, 4096
  s_waitcnt lgkmcnt(0)
  buffer_store_dwordx4 a[188:191], v0, s[28:31], s74 offen offset:0 sc1
  buffer_store_dwordx4 a[192:195], v0, s[28:31], s74 offen offset:1024 sc1
  buffer_store_dwordx4 a[196:199], v0, s[28:31], s74 offen offset:2048 sc1
  buffer_store_dwordx4 a[200:203], v0, s[28:31], s74 offen offset:3072 sc1
  buffer_store_dwordx4 a[204:207], v0, s[28:31], s50 offen offset:0 sc1
  buffer_store_dwordx4 a[208:211], v0, s[28:31], s50 offen offset:1024 sc1
  buffer_store_dwordx4 a[212:215], v0, s[28:31], s50 offen offset:2048 sc1
  s_add_u32 s50, s54, 4096
  buffer_store_dwordx4 a[216:219], v0, s[28:31], s54 offen offset:0 sc1
  buffer_store_dwordx4 a[220:223], v0, s[28:31], s54 offen offset:1024 sc1
  buffer_store_dwordx4 a[224:227], v0, s[28:31], s54 offen offset:2048 sc1
  buffer_store_dwordx4 a[228:231], v0, s[28:31], s54 offen offset:3072 sc1
  buffer_store_dwordx4 a[232:235], v0, s[28:31], s50 offen offset:0 sc1
  buffer_store_dwordx4 a[236:239], v0, s[28:31], s50 offen offset:1024 sc1
  buffer_store_dwordx4 a[240:243], v240, s[28:31], s50 offen offset:2048 sc1
  buffer_store_dword v227, v238, s[28:31], s50 offen offset:2048 sc1
  s_cmp_lt_u32 s3, 13
  s_cbranch_scc0 standalone__cross_network_dcn_v2__recsys_kernel_Rnp1s
  s_barrier
  s_waitcnt vmcnt(15)
  s_branch standalone__cross_network_dcn_v2__recsys_kernel_RA3
standalone__cross_network_dcn_v2__recsys_kernel_RA3:
  s_barrier
  s_waitcnt vmcnt(0)
  s_mov_b64 exec, 1
  buffer_atomic_add v236, off, s[44:47], 0 offset:252
  s_mov_b64 exec, -1
  s_branch standalone__cross_network_dcn_v2__recsys_kernel_Rnp1s
standalone__cross_network_dcn_v2__recsys_kernel_lookB:
  v_lshrrev_b32 v251, 2, v0
  v_min_u32 v251, 0xcc, v251
  buffer_load_dword v250, v251, s[44:47], 0 offen
  s_branch standalone__cross_network_dcn_v2__recsys_kernel_lookBret
standalone__cross_network_dcn_v2__recsys_kernel_pollB:
  s_waitcnt vmcnt(12)
  v_cmp_ne_u32 vcc, 1, v250
  s_mov_b32 s50, 0
  s_cbranch_vccz standalone__cross_network_dcn_v2__recsys_kernel_pollBok
standalone__cross_network_dcn_v2__recsys_kernel_pollBspin:
  buffer_load_dword v250, v251, s[44:47], 0 offen sc1
  s_waitcnt vmcnt(0)
  v_cmp_ne_u32 vcc, 1, v250
  s_add_u32 s50, s50, 1
  s_cbranch_vccz standalone__cross_network_dcn_v2__recsys_kernel_pollBok
  s_cmp_lt_u32 s50, 4000
  s_cbranch_scc1 standalone__cross_network_dcn_v2__recsys_kernel_pollBspin
  s_mov_b32 s19, 1
  s_branch standalone__cross_network_dcn_v2__recsys_kernel_fb
standalone__cross_network_dcn_v2__recsys_kernel_pollBok:
  s_mov_b32 s19, 2
  s_branch standalone__cross_network_dcn_v2__recsys_kernel_pollBret
standalone__cross_network_dcn_v2__recsys_kernel_fb:
  s_waitcnt vmcnt(0) lgkmcnt(0)
  s_nop 15
  s_nop 15
  s_mov_b32 s84, s28
  s_mov_b32 s85, s29
  s_mov_b32 s86, s30
  s_mov_b32 s28, s16
  s_mov_b32 s29, s17
  s_mov_b32 s30, 1051392
  s_mov_b32 s71, 26
  s_mov_b32 s75, 155648
  v_add_u32 v254, 129024, v0
  ds_write_b128 v254, v[12:15] offset:0
  ds_write_b128 v254, v[16:19] offset:1024
  ds_write_b128 v254, v[20:23] offset:2048
  ds_write_b128 v254, v[24:27] offset:3072
  ds_write_b128 v254, v[28:31] offset:4096
  ds_write_b128 v254, v[32:35] offset:5120
  ds_write_b128 v254, v[36:39] offset:6144
  ds_write_b128 v254, v[40:43] offset:7168
  ds_write_b128 v254, v[44:47] offset:8192
  ds_write_b128 v254, v[48:51] offset:9216
  ds_write_b128 v254, v[52:55] offset:10240
  s_waitcnt lgkmcnt(0)
  v_lshrrev_b32 v52, 4, v0
standalone__cross_network_dcn_v2__recsys_kernel_fbl:
  s_mul_i32 s50, s71, 2521
  s_lshr_b32 s50, s50, 16
  s_mul_i32 s51, s50, 26
  s_sub_u32 s72, s71, s51
  s_add_u32 s51, s72, 13
  s_sub_u32 s52, s72, 13
  s_cmp_lt_u32 s72, 13
  s_cselect_b32 s72, s51, s52
  s_mul_i32 s73, s50, 86528
  s_mul_i32 s74, s50, 175232
  v_and_b32 v40, 31, v52
  v_lshrrev_b32 v41, 5, v52
  v_and_b32 v42, 0x13, v40
  v_and_b32 v43, 4, v40
  v_lshlrev_b32 v43, 1, v43
  v_or_b32 v42, v42, v43
  v_and_b32 v43, 8, v40
  v_lshrrev_b32 v43, 1, v43
  v_or_b32 v42, v42, v43
  v_lshlrev_b32 v41, 4, v41
  s_cmp_lt_u32 s72, 13
  s_cbranch_scc1 standalone__cross_network_dcn_v2__recsys_kernel_f_lu
  s_cmp_eq_u32 s72, 25
  s_cbranch_scc1 standalone__cross_network_dcn_v2__recsys_kernel_f_l3
  s_sub_u32 s51, s72, 13
  s_lshr_b32 s52, s51, 2
  s_mul_i32 s53, s52, 26624
  s_add_u32 s73, s73, s53
  s_mul_i32 s53, s52, 46976
  s_add_u32 s74, s74, s53
  s_bfe_u32 s52, s51, 0x10001
  s_and_b32 s51, s51, 1
  s_mul_i32 s53, s52, 3328
  s_add_u32 s73, s73, s53
  s_mul_i32 s53, s51, 448
  s_add_u32 s73, s73, s53
  s_mul_i32 s53, s52, 13312
  s_add_u32 s74, s74, s53
  s_mul_i32 s53, s51, 7168
  s_add_u32 s74, s74, s53
  v_and_b32 v40, 15, v52
  v_mul_u32_u24 v43, 448, v40
  v_lshrrev_b32 v41, 4, v52
  v_lshlrev_b32 v41, 4, v41
  v_add3_u32 v43, v43, v41, s75
  v_add_u32 v40, 0, v52
  v_mul_u32_u24 v41, 2341, v40
  v_lshrrev_b32 v41, 16, v41
  v_mul_u32_u24 v42, 28, v41
  v_sub_u32 v40, v40, v42
  v_lshlrev_b32 v40, 4, v40
  v_and_b32 v42, 12, v41
  v_add_u32 v41, v41, v42
  v_mul_u32_u24 v41, 832, v41
  v_add_u32 v44, v40, v41
  v_add_u32 v40, 64, v52
  v_mul_u32_u24 v41, 2341, v40
  v_lshrrev_b32 v41, 16, v41
  v_mul_u32_u24 v42, 28, v41
  v_sub_u32 v40, v40, v42
  v_lshlrev_b32 v40, 4, v40
  v_and_b32 v42, 12, v41
  v_add_u32 v41, v41, v42
  v_mul_u32_u24 v41, 832, v41
  v_add_u32 v45, v40, v41
  v_add_u32 v40, 128, v52
  v_mul_u32_u24 v41, 2341, v40
  v_lshrrev_b32 v41, 16, v41
  v_mul_u32_u24 v42, 28, v41
  v_sub_u32 v40, v40, v42
  v_lshlrev_b32 v40, 4, v40
  v_and_b32 v42, 12, v41
  v_add_u32 v41, v41, v42
  v_mul_u32_u24 v41, 832, v41
  v_add_u32 v46, v40, v41
  v_add_u32 v40, 192, v52
  v_mul_u32_u24 v41, 2341, v40
  v_lshrrev_b32 v41, 16, v41
  v_mul_u32_u24 v42, 28, v41
  v_sub_u32 v40, v40, v42
  v_lshlrev_b32 v40, 4, v40
  v_and_b32 v42, 12, v41
  v_add_u32 v41, v41, v42
  v_mul_u32_u24 v41, 832, v41
  v_add_u32 v47, v40, v41
  v_add_u32 v40, 256, v52
  v_mul_u32_u24 v41, 2341, v40
  v_lshrrev_b32 v41, 16, v41
  v_mul_u32_u24 v42, 28, v41
  v_sub_u32 v40, v40, v42
  v_lshlrev_b32 v40, 4, v40
  v_and_b32 v42, 12, v41
  v_add_u32 v41, v41, v42
  v_mul_u32_u24 v41, 832, v41
  v_add_u32 v48, v40, v41
  v_add_u32 v40, 320, v52
  v_mul_u32_u24 v41, 2341, v40
  v_lshrrev_b32 v41, 16, v41
  v_mul_u32_u24 v42, 28, v41
  v_sub_u32 v40, v40, v42
  v_lshlrev_b32 v40, 4, v40
  v_and_b32 v42, 12, v41
  v_add_u32 v41, v41, v42
  v_mul_u32_u24 v41, 832, v41
  v_add_u32 v49, v40, v41
  v_add_u32 v40, 384, v52
  v_mul_u32_u24 v41, 2341, v40
  v_lshrrev_b32 v41, 16, v41
  v_mul_u32_u24 v42, 28, v41
  v_sub_u32 v40, v40, v42
  v_lshlrev_b32 v40, 4, v40
  v_and_b32 v42, 12, v41
  v_add_u32 v41, v41, v42
  v_mul_u32_u24 v41, 832, v41
  v_add_u32 v50, v40, v41
  s_add_u32 m0, s75, 0
  s_nop 0
  buffer_load_dwordx4 v44, s[32:35], s73 offen lds
  s_add_u32 m0, s75, 1024
  s_nop 0
  buffer_load_dwordx4 v45, s[32:35], s73 offen lds
  s_add_u32 m0, s75, 2048
  s_nop 0
  buffer_load_dwordx4 v46, s[32:35], s73 offen lds
  s_add_u32 m0, s75, 3072
  s_nop 0
  buffer_load_dwordx4 v47, s[32:35], s73 offen lds
  s_add_u32 m0, s75, 4096
  s_nop 0
  buffer_load_dwordx4 v48, s[32:35], s73 offen lds
  s_add_u32 m0, s75, 5120
  s_nop 0
  buffer_load_dwordx4 v49, s[32:35], s73 offen lds
  s_add_u32 m0, s75, 6144
  s_nop 0
  buffer_load_dwordx4 v50, s[32:35], s73 offen lds
  s_branch standalone__cross_network_dcn_v2__recsys_kernel_f_ldone
standalone__cross_network_dcn_v2__recsys_kernel_f_l3:
  v_and_b32 v40, 15, v52
  v_lshrrev_b32 v41, 2, v40
  v_lshlrev_b32 v41, 1, v41
  v_and_b32 v42, 1, v40
  v_add_u32 v41, v41, v42
  v_mul_u32_u24 v41, 832, v41
  v_and_b32 v42, 2, v40
  v_lshlrev_b32 v42, 5, v42
  v_lshrrev_b32 v43, 4, v52
  v_lshlrev_b32 v43, 4, v43
  v_add3_u32 v43, v41, v42, v43
  v_add_u32 v43, s75, v43
  s_add_u32 s74, s74, 140928
  s_add_u32 s73, s73, 79872
  s_mov_b32 m0, s75
  s_nop 0
  buffer_load_dwordx4 v0, s[32:35], s73 offen offset:0 lds
  buffer_load_dwordx4 v0, s[32:35], s73 offen offset:1024 lds
  buffer_load_dwordx4 v0, s[32:35], s73 offen offset:2048 lds
  buffer_load_dwordx4 v0, s[32:35], s73 offen offset:3072 lds
  s_add_u32 m0, s75, 4096
  s_add_u32 s73, s73, 4096
  buffer_load_dwordx4 v0, s[32:35], s73 offen offset:0 lds
  buffer_load_dwordx4 v0, s[32:35], s73 offen offset:1024 lds
  buffer_load_dwordx4 v0, s[32:35], s73 offen offset:2048 lds
  s_branch standalone__cross_network_dcn_v2__recsys_kernel_f_ldone
standalone__cross_network_dcn_v2__recsys_kernel_f_lu:
  s_mul_i32 s53, s72, 6656
  s_add_u32 s73, s73, s53
  s_mul_i32 s51, s72, 86
  s_lshr_b32 s51, s51, 8
  s_min_u32 s51, s51, 3
  s_mul_i32 s52, s51, 3
  s_sub_u32 s52, s72, s52
  s_mul_i32 s53, s51, 46976
  s_add_u32 s74, s74, s53
  s_mul_i32 s53, s52, 6784
  s_add_u32 s74, s74, s53
  s_cmp_eq_u32 s51, 3
  s_cselect_b32 s53, 7, 26
  s_lshl_b32 s53, s53, 10
  s_add_u32 s74, s74, s53
  v_mul_u32_u24 v43, 208, v42
  v_add3_u32 v43, v43, v41, s75
  s_mul_i32 s50, s50, 832
  s_lshl_b32 s51, s72, 6
  s_add_u32 s50, s50, s51
  v_lshlrev_b32 v42, 1, v42
  s_mov_b32 m0, s75
  s_nop 0
  buffer_load_dwordx4 v0, s[36:39], s73 offen offset:0 lds
  buffer_load_dwordx4 v0, s[36:39], s73 offen offset:1024 lds
  buffer_load_dwordx4 v0, s[36:39], s73 offen offset:2048 lds
  buffer_load_dwordx4 v0, s[36:39], s73 offen offset:3072 lds
  s_add_u32 m0, s75, 4096
  s_add_u32 s73, s73, 4096
  buffer_load_dwordx4 v0, s[36:39], s73 offen offset:0 lds
  buffer_load_dwordx4 v0, s[36:39], s73 offen offset:1024 lds
  buffer_load_dwordx4 v0, s[36:39], s73 offen offset:2048 lds
  buffer_load_ushort v44, v42, s[40:43], s50 offen
standalone__cross_network_dcn_v2__recsys_kernel_f_ldone:
  s_waitcnt vmcnt(0)
  s_cmp_eq_u32 s72, 25
  s_cbranch_scc1 standalone__cross_network_dcn_v2__recsys_kernel_f_r3
  s_cmp_lt_u32 s72, 13
  s_cbranch_scc1 standalone__cross_network_dcn_v2__recsys_kernel_f_ru
  ds_read_b128 v[12:15], v43 offset:0
  ds_read_b128 v[16:19], v43 offset:64
  ds_read_b128 v[20:23], v43 offset:128
  ds_read_b128 v[24:27], v43 offset:192
  ds_read_b128 v[28:31], v43 offset:256
  ds_read_b128 v[32:35], v43 offset:320
  ds_read_b128 v[36:39], v43 offset:384
  s_branch standalone__cross_network_dcn_v2__recsys_kernel_f_rdone
standalone__cross_network_dcn_v2__recsys_kernel_f_ru:
  ds_read_b128 v[12:15], v43 offset:0
  ds_read_b128 v[16:19], v43 offset:32
  ds_read_b128 v[20:23], v43 offset:64
  ds_read_b128 v[24:27], v43 offset:96
  ds_read_b128 v[28:31], v43 offset:128
  ds_read_b128 v[32:35], v43 offset:160
  ds_read_b128 v[36:39], v43 offset:192
  s_branch standalone__cross_network_dcn_v2__recsys_kernel_f_rdone
standalone__cross_network_dcn_v2__recsys_kernel_f_r3:
  ds_read_b128 v[12:15], v43 offset:0
  ds_read_b128 v[16:19], v43 offset:128
  ds_read_b128 v[20:23], v43 offset:256
  ds_read_b128 v[24:27], v43 offset:384
  ds_read_b128 v[28:31], v43 offset:512
  ds_read_b128 v[32:35], v43 offset:640
  ds_read_b128 v[36:39], v43 offset:768
standalone__cross_network_dcn_v2__recsys_kernel_f_rdone:
  s_add_u32 s50, s74, 4096
  s_waitcnt lgkmcnt(0)
  buffer_store_dwordx4 v[12:15], v0, s[28:31], s74 offen offset:0 sc1
  buffer_store_dwordx4 v[16:19], v0, s[28:31], s74 offen offset:1024 sc1
  buffer_store_dwordx4 v[20:23], v0, s[28:31], s74 offen offset:2048 sc1
  buffer_store_dwordx4 v[24:27], v0, s[28:31], s74 offen offset:3072 sc1
  buffer_store_dwordx4 v[28:31], v0, s[28:31], s50 offen sc1
  buffer_store_dwordx4 v[32:35], v0, s[28:31], s50 offen offset:1024 sc1
  s_cmp_lt_u32 s72, 13
  s_cbranch_scc1 standalone__cross_network_dcn_v2__recsys_kernel_f_su
  s_bitcmp0_b32 s72, 0
  s_cbranch_scc1 standalone__cross_network_dcn_v2__recsys_kernel_f_sdone
  buffer_store_dwordx4 v[36:39], v0, s[28:31], s50 offen offset:2048 sc1
  s_branch standalone__cross_network_dcn_v2__recsys_kernel_f_sdone
standalone__cross_network_dcn_v2__recsys_kernel_f_su:
  v_mov_b32 v41, 1073741824
  v_cmp_gt_u32 vcc, 512, v0
  v_add_u32 v42, 128, v0
  v_lshrrev_b32 v40, 2, v0
  v_cndmask_b32 v42, v41, v42, vcc
  v_cndmask_b32 v40, v41, v40, vcc
  buffer_store_dwordx4 v[36:39], v42, s[28:31], s50 offen offset:2048 sc1
  buffer_store_dword v44, v40, s[28:31], s50 offen offset:2048 sc1
standalone__cross_network_dcn_v2__recsys_kernel_f_sdone:
  s_waitcnt vmcnt(0)
  s_add_u32 s71, s71, 1
  s_cmp_lt_u32 s71, 156
  s_cbranch_scc1 standalone__cross_network_dcn_v2__recsys_kernel_fbl
  ds_read_b128 v[12:15], v254 offset:0
  ds_read_b128 v[16:19], v254 offset:1024
  ds_read_b128 v[20:23], v254 offset:2048
  ds_read_b128 v[24:27], v254 offset:3072
  ds_read_b128 v[28:31], v254 offset:4096
  ds_read_b128 v[32:35], v254 offset:5120
  ds_read_b128 v[36:39], v254 offset:6144
  ds_read_b128 v[40:43], v254 offset:7168
  ds_read_b128 v[44:47], v254 offset:8192
  ds_read_b128 v[48:51], v254 offset:9216
  ds_read_b128 v[52:55], v254 offset:10240
  s_mov_b32 s28, s84
  s_mov_b32 s29, s85
  s_mov_b32 s30, s86
  s_waitcnt lgkmcnt(0)
  s_cmp_eq_u32 s19, 1
  s_cbranch_scc1 standalone__cross_network_dcn_v2__recsys_kernel_pollBok
  s_mov_b32 s19, 2
  s_branch standalone__cross_network_dcn_v2__recsys_kernel_pollAok
.section .rodata,"a"
.p2align 6
.amdhsa_kernel standalone__cross_network_dcn_v2__recsys_kernel
  .amdhsa_next_free_vgpr 512
  .amdhsa_next_free_sgpr 102
  .amdhsa_accum_offset 256
  .amdhsa_group_segment_fixed_size 0
  .amdhsa_kernarg_size 56
  .amdhsa_user_sgpr_count 2
  .amdhsa_user_sgpr_kernarg_segment_ptr 1
  .amdhsa_system_sgpr_workgroup_id_x 1
.end_amdhsa_kernel
.text
```
